```python
import torch

def _softmax(x, axis=-1):
    return torch.softmax(x, dim=axis)
def _gelu(x):
    return torch.nn.functional.gelu(x, approximate="tanh")
def _silu(x):
    return torch.nn.functional.silu(x)
def _sigmoid(x):
    return torch.sigmoid(x)
def _layernorm(x, axis=-1, eps=1e-5):
    m = x.mean(dim=axis, keepdim=True)
    v = x.var(dim=axis, keepdim=True, unbiased=False)
    return (x - m) / torch.sqrt(v + eps)
def _scatter_add(tgt, idx, src, axis=0):
    return tgt.clone().index_add_(axis, idx, src)
def _segment_sum(src, seg, n):
    out = torch.zeros((n,) + src.shape[1:], dtype=src.dtype)
    return out.index_add_(0, seg, src)
def _pad(x, pw):
    flat = tuple(v for pair in reversed(pw) for v in pair)
    return torch.nn.functional.pad(x, flat)

kernel_name = 'recurrent_scan__compressed_kv_cla__geglu_ffn__prompt'

def setup_inputs():

    _w = (lambda a: (lambda t: t.to(torch.bfloat16) if t.is_floating_point() else t)(torch.as_tensor(a)))
    def _A_setup():
        B, H, Sq, Sk, D, M = 1, 32, 2048, 2048, 128, 512
        Dc = 4 * D
        return {
            "x": _w((lambda *s: torch.randn(*s, dtype=torch.bfloat16) * 0.05)(B, Sq, M)),
            "c_kv": _w((lambda *s: torch.randn(*s, dtype=torch.bfloat16) * 0.2)(B, Sk, Dc)),
            "w_q": _w((lambda *s: torch.randn(*s, dtype=torch.bfloat16) * 3.2)(M, H, D) * (M ** -0.5)),
            "w_uk": _w((lambda *s: torch.randn(*s, dtype=torch.bfloat16) * 3.2)(Dc, H, D) * (Dc ** -0.5)),
            "w_uv": _w((lambda *s: torch.randn(*s, dtype=torch.bfloat16) * 0.2)(Dc, H, D) * (Dc ** -0.5)),
            "w_o": _w((lambda *s: torch.randn(*s, dtype=torch.bfloat16) * 0.2)(H, D, M) * ((H * D) ** -0.5)),
        }
    _A_in = _A_setup()

    def _B_setup():
        B, S, D, F = 1, 2048, 512, 1376
        return {
            "x": _w((lambda *s: torch.randn(*s, dtype=torch.bfloat16) * 0.05)(B, S, D)),
            "w_gate": _w((lambda *s: torch.randn(*s, dtype=torch.bfloat16) * 0.1)(D, F)),
            "w_up": _w((lambda *s: torch.randn(*s, dtype=torch.bfloat16) * 0.1)(D, F)),
            "w_down": _w((lambda *s: torch.randn(*s, dtype=torch.bfloat16) * 0.1)(F, D)),
        }
    _B_in = _B_setup()

    return {
        "A_x": _A_in["x"],
        "A_c_kv": _A_in["c_kv"],
        "A_w_q": _A_in["w_q"],
        "A_w_uk": _A_in["w_uk"],
        "A_w_uv": _A_in["w_uv"],
        "A_w_o": _A_in["w_o"],
        "B_x": _B_in["x"],
        "B_w_gate": _B_in["w_gate"],
        "B_w_up": _B_in["w_up"],
        "B_w_down": _B_in["w_down"],
    }

def reference(A_x, A_c_kv, A_w_q, A_w_uk, A_w_uv, A_w_o, B_x, B_w_gate, B_w_up, B_w_down):
    def _A_ref(x, c_kv, w_q, w_uk, w_uv, w_o):
        B, Sq, M = x.shape[0], x.shape[1], x.shape[2]
        Sk = c_kv.shape[1]
        H, D = w_q.shape[1], w_q.shape[2]
        q = torch.einsum("bqm,mhd->bhqd", x, w_q)
        k = torch.einsum("bkc,chd->bhkd", c_kv, w_uk)
        v = torch.einsum("bkc,chd->bhkd", c_kv, w_uv)
        scores = torch.einsum("bhqd,bhkd->bhqk", q, k) * (D ** -0.5)
        off = Sk - Sq
        qi = torch.arange(Sq)[:, None]
        kj = torch.arange(Sk)[None, :]
        cmask = kj <= (qi + off)
        scores = torch.where(cmask[None, None], scores, -1e9)
        p = _softmax(scores, axis=-1)
        ctx = torch.einsum("bhqk,bhkd->bhqd", p, v)
        return torch.einsum("bhqd,hdm->bqm", ctx, w_o)

    def _B_ref(x, w_gate, w_up, w_down):
        return (_gelu(x @ w_gate) * (x @ w_up)) @ w_down

    x = A_x
    xn = _layernorm(x, axis=-1)
    s = _A_ref(xn, A_c_kv, A_w_q, A_w_uk, A_w_uv, A_w_o)
    g = _silu(_B_ref(xn, B_w_gate, B_w_up, B_w_down))
    return x + s * g
```

```asm
; @launch kernel=main_kernel grid=(256,1,1) block=(512,1,1) lds=163840
.amdgcn_target "amdgcn-amd-amdhsa--gfx950"
.text
.globl main_kernel
.p2align 8
.type main_kernel,@function
main_kernel:
  s_cmp_ge_u32 s2, 256
  s_cbranch_scc1 L_main_exit
  s_load_dwordx16 s[16:31], s[0:1], 0
  s_load_dwordx8 s[32:39], s[0:1], 64
  s_load_dwordx2 s[40:41], s[0:1], 96
  v_lshrrev_b32 v2, 6, v0
  v_and_b32 v1, 63, v0
  v_readfirstlane_b32 s3, v2
  s_and_b32 s62, s2, 7
  s_lshr_b32 s65, s2, 3
  s_lshl_b32 s60, s62, 2
  s_and_b32 s66, s65, 3
  s_add_u32 s60, s60, s66
  s_lshr_b32 s61, s65, 2
  s_lshr_b32 s63, s3, 2
  s_and_b32 s64, s3, 3
  v_lshlrev_b32 v2, 4, v1
  v_lshrrev_b32 v17, 4, v1
  v_bfe_u32 v19, v1, 2, 2
  v_and_b32 v20, 3, v1
  v_lshlrev_b32 v21, 1, v17
  s_mov_b32 s67, 0x78
  v_lshrrev_b32 v21, v21, s67
  v_and_b32 v21, 3, v21
  v_xor_b32 v21, v21, v20
  v_lshrrev_b32 v22, 2, v1
  s_lshl_b32 s65, s3, 15
  v_lshlrev_b32 v22, 10, v22
  v_lshl_add_u32 v22, v21, 4, v22
  v_add_u32 v7, s65, v22
  s_and_b32 s66, s3, 2
  v_xor_b32 v26, s66, v20
  s_lshl_b32 s65, s3, 2
  v_add_u32 v24, s65, v19
  v_lshlrev_b32 v25, 6, v17
  v_lshl_add_u32 v25, v26, 4, v25
  v_lshl_add_u32 v9, v24, 13, v25
  s_lshl_b32 s70, s3, 11
  s_lshl_b32 s68, s61, 18
  s_lshl_b32 s69, s60, 8
  s_lshl_b32 s85, s2, 3
  s_add_u32 s85, s85, s3
  s_waitcnt lgkmcnt(0)
  s_mov_b32 s28, s70
  s_mov_b32 s8, s16
  s_mov_b32 s9, s17
  s_mov_b32 s10, 2097152
  s_mov_b32 s11, 0x00020000
  s_lshl_b32 s65, s85, 10
  buffer_load_dwordx4 v[96:99], v2, s[8:11], s65 offen
  s_mov_b32 s44, s18
  s_mov_b32 s45, s19
  s_mov_b32 s46, 2097152
  s_mov_b32 s47, 0x00020000
  s_mov_b32 s48, s22
  s_mov_b32 s49, s23
  s_mov_b32 s50, 4194304
  s_mov_b32 s51, 0x00020000
  s_mov_b32 s52, s24
  s_mov_b32 s53, s25
  s_mov_b32 s54, 4194304
  s_mov_b32 s55, 0x00020000
  s_mov_b32 s71, 4
L_pro_dma:
  s_add_u32 m0, s28, 0
  s_add_u32 s65, s68, 0
  buffer_load_dwordx4 v7, s[44:47], s65 offen lds
  s_add_u32 m0, s28, 1024
  s_add_u32 s65, s68, 16384
  buffer_load_dwordx4 v7, s[44:47], s65 offen lds
  s_add_u32 m0, s28, 16384
  s_nop 0
  buffer_load_dwordx4 v9, s[48:51], s69 offen lds
  s_add_u32 m0, s28, 17408
  s_nop 0
  buffer_load_dwordx4 v9, s[52:55], s69 offen lds
  s_add_u32 s68, s68, 64
  s_add_u32 s69, s69, 262144
  s_add_u32 s28, s28, 32768
  s_and_b32 s28, s28, 0x1ffff
  s_barrier
  s_sub_u32 s71, s71, 1
  s_cmp_lg_u32 s71, 0
  s_cbranch_scc1 L_pro_dma
  s_lshr_b32 s17, s70, 1
  s_add_u32 s17, s17, 131072
  s_getpc_b64 s[12:13]
  s_mov_b32 s14, 24576
  s_mov_b32 s15, 0x00020000
  s_mov_b32 m0, s17
  s_lshr_b32 s65, s70, 1
  s_add_u32 s65, s65, 4096
  buffer_load_dwordx4 v2, s[12:15], s65 offen lds
  s_add_u32 s65, s65, 8192
  buffer_load_dwordx4 v2, s[12:15], s65 offen lds
  s_add_u32 s65, s65, 8192
  s_mov_b32 s56, s40
  s_mov_b32 s57, s41
  s_mov_b32 s58, 268435456
  s_mov_b32 s59, 0x00020000
  s_mov_b32 s4, s38
  s_mov_b32 s5, s39
  s_mov_b32 s6, 256
  s_mov_b32 s7, 0x00020000
  s_mov_b32 s12, s20
  s_mov_b32 s13, s21
  s_mov_b32 s14, 4194304
  s_mov_b32 s15, 0x00020000
  s_and_b32 s66, s64, 1
  s_lshl_b32 s66, s66, 1
  v_xor_b32 v26, s66, v20
  v_lshrrev_b32 v24, 5, v1
  v_lshl_add_u32 v24, v24, 2, v19
  s_lshl_b32 s65, s64, 3
  v_add_u32 v24, s65, v24
  v_mul_u32_u24 v24, 2752, v24
  v_and_b32 v25, 1, v17
  v_lshl_add_u32 v24, v25, 6, v24
  v_lshl_add_u32 v10, v26, 4, v24
  v_and_b32 v16, 15, v1
  v_lshlrev_b32 v21, 1, v19
  s_mov_b32 s67, 0x78
  v_lshrrev_b32 v21, v21, s67
  v_and_b32 v21, 3, v21
  v_xor_b32 v21, v21, v17
  s_lshl_b32 s65, s63, 13
  v_lshlrev_b32 v22, 6, v16
  v_lshl_add_u32 v22, v21, 4, v22
  v_add_u32 v3, s65, v22
  v_and_b32 v21, 1, v17
  v_lshlrev_b32 v22, 12, v17
  v_lshl_add_u32 v22, v19, 6, v22
  v_lshl_add_u32 v22, v20, 3, v22
  s_lshl_b32 s65, s64, 8
  v_add_u32 v22, s65, v22
  v_lshl_add_u32 v14, v21, 5, v22
  v_xor_b32 v15, 32, v14
  v_add_u32 v5, 16384, v14
  v_add_u32 v6, 16384, v15
  s_lshl_b32 s29, s60, 8
  s_mul_i32 s43, s60, 96
  s_lshr_b32 s16, s70, 1
  s_lshl_b32 s72, s60, 7
  s_lshl_b32 s65, s61, 4
  s_add_u32 s72, s72, s65
  s_lshl_b32 s65, s63, 3
  s_add_u32 s72, s72, s65
  s_lshl_b32 s73, s72, 2
  s_lshl_b32 s72, s72, 2
  s_add_u32 s72, s72, s64
  s_lshl_b32 s72, s72, 10
  s_add_u32 s72, s72, 2097152
  s_lshl_b32 s65, s64, 1
  s_add_u32 s73, s73, s65
  s_lshl_b32 s73, s73, 10
  s_add_u32 s73, s73, 18874368
  s_sub_u32 s65, s61, 2
  s_lshl_b32 s65, s65, 2
  s_and_b32 s66, s60, 3
  s_add_u32 s65, s65, s66
  s_cmp_lt_u32 s65, 22
  s_cselect_b32 s78, 1, 0
  s_cselect_b32 s65, s65, 0
  s_mul_i32 s66, s62, 22
  s_add_u32 s65, s65, s66
  s_lshr_b32 s79, s65, 4
  s_and_b32 s80, s65, 15
  s_lshl_b32 s74, s80, 3
  s_add_u32 s74, s74, s3
  s_lshl_b32 s74, s74, 14
  s_lshl_b32 s75, s79, 8
  s_lshl_b32 s77, s79, 2
  s_add_u32 s77, s77, s64
  s_lshl_b32 s76, s80, 3
  s_lshl_b32 s65, s63, 2
  s_add_u32 s76, s76, s65
  s_mul_i32 s76, s76, 43
  s_add_u32 s76, s76, s77
  s_lshl_b32 s76, s76, 10
  s_add_u32 s76, s76, 52428800
  s_sub_u32 s65, 15, s61
  s_lshl_b32 s81, s65, 1
  s_add_u32 s81, s81, 2
  s_cmp_eq_u32 s63, 0
  s_cselect_b32 s65, s65, s61
  s_lshl_b32 s82, s65, 1
  s_add_u32 s82, s82, 2
  s_lshl_b32 s83, s65, 2
  s_add_u32 s83, s83, s64
  s_lshl_b32 s84, s83, 15
  v_mov_b32 v128, 0
  v_mov_b32 v129, 0
  v_mov_b32 v130, 0
  v_mov_b32 v131, 0
  v_mov_b32 v132, 0
  v_mov_b32 v133, 0
  v_mov_b32 v134, 0
  v_mov_b32 v135, 0
  v_mov_b32 v136, 0
  v_mov_b32 v137, 0
  v_mov_b32 v138, 0
  v_mov_b32 v139, 0
  v_mov_b32 v140, 0
  v_mov_b32 v141, 0
  v_mov_b32 v142, 0
  v_mov_b32 v143, 0
  v_mov_b32 v144, 0
  v_mov_b32 v145, 0
  v_mov_b32 v146, 0
  v_mov_b32 v147, 0
  v_mov_b32 v148, 0
  v_mov_b32 v149, 0
  v_mov_b32 v150, 0
  v_mov_b32 v151, 0
  v_mov_b32 v152, 0
  v_mov_b32 v153, 0
  v_mov_b32 v154, 0
  v_mov_b32 v155, 0
  v_mov_b32 v156, 0
  v_mov_b32 v157, 0
  v_mov_b32 v158, 0
  v_mov_b32 v159, 0
  v_mov_b32 v160, 0
  v_mov_b32 v161, 0
  v_mov_b32 v162, 0
  v_mov_b32 v163, 0
  v_mov_b32 v164, 0
  v_mov_b32 v165, 0
  v_mov_b32 v166, 0
  v_mov_b32 v167, 0
  v_mov_b32 v168, 0
  v_mov_b32 v169, 0
  v_mov_b32 v170, 0
  v_mov_b32 v171, 0
  v_mov_b32 v172, 0
  v_mov_b32 v173, 0
  v_mov_b32 v174, 0
  v_mov_b32 v175, 0
  v_mov_b32 v176, 0
  v_mov_b32 v177, 0
  v_mov_b32 v178, 0
  v_mov_b32 v179, 0
  v_mov_b32 v180, 0
  v_mov_b32 v181, 0
  v_mov_b32 v182, 0
  v_mov_b32 v183, 0
  v_mov_b32 v184, 0
  v_mov_b32 v185, 0
  v_mov_b32 v186, 0
  v_mov_b32 v187, 0
  v_mov_b32 v188, 0
  v_mov_b32 v189, 0
  v_mov_b32 v190, 0
  v_mov_b32 v191, 0
  v_mov_b32 v192, 0
  v_mov_b32 v193, 0
  v_mov_b32 v194, 0
  v_mov_b32 v195, 0
  v_mov_b32 v196, 0
  v_mov_b32 v197, 0
  v_mov_b32 v198, 0
  v_mov_b32 v199, 0
  v_mov_b32 v200, 0
  v_mov_b32 v201, 0
  v_mov_b32 v202, 0
  v_mov_b32 v203, 0
  v_mov_b32 v204, 0
  v_mov_b32 v205, 0
  v_mov_b32 v206, 0
  v_mov_b32 v207, 0
  v_mov_b32 v208, 0
  v_mov_b32 v209, 0
  v_mov_b32 v210, 0
  v_mov_b32 v211, 0
  v_mov_b32 v212, 0
  v_mov_b32 v213, 0
  v_mov_b32 v214, 0
  v_mov_b32 v215, 0
  v_mov_b32 v216, 0
  v_mov_b32 v217, 0
  v_mov_b32 v218, 0
  v_mov_b32 v219, 0
  v_mov_b32 v220, 0
  v_mov_b32 v221, 0
  v_mov_b32 v222, 0
  v_mov_b32 v223, 0
  v_mov_b32 v224, 0
  v_mov_b32 v225, 0
  v_mov_b32 v226, 0
  v_mov_b32 v227, 0
  v_mov_b32 v228, 0
  v_mov_b32 v229, 0
  v_mov_b32 v230, 0
  v_mov_b32 v231, 0
  v_mov_b32 v232, 0
  v_mov_b32 v233, 0
  v_mov_b32 v234, 0
  v_mov_b32 v235, 0
  v_mov_b32 v236, 0
  v_mov_b32 v237, 0
  v_mov_b32 v238, 0
  v_mov_b32 v239, 0
  v_mov_b32 v240, 0
  v_mov_b32 v241, 0
  v_mov_b32 v242, 0
  v_mov_b32 v243, 0
  v_mov_b32 v244, 0
  v_mov_b32 v245, 0
  v_mov_b32 v246, 0
  v_mov_b32 v247, 0
  v_mov_b32 v248, 0
  v_mov_b32 v249, 0
  v_mov_b32 v250, 0
  v_mov_b32 v251, 0
  v_mov_b32 v252, 0
  v_mov_b32 v253, 0
  v_mov_b32 v254, 0
  v_mov_b32 v255, 0
  v_lshrrev_b32 v30, 2, v1
  v_and_b32 v31, 3, v1
  v_lshlrev_b32 v30, 10, v30
  v_lshl_add_u32 v30, v31, 8, v30
  s_lshl_b32 s65, s2, 8
  s_lshl_b32 s66, s3, 16
  s_add_u32 s65, s65, s66
  s_add_u32 s65, s65, 100663296
  s_lshr_b32 s66, s2, 6
  s_lshr_b32 s67, s3, 2
  s_or_b32 s66, s66, s67
  s_cmp_eq_u32 s66, 0
  s_cselect_b32 s65, s65, 268435456
  v_mov_b32 v0, 0
  v_lshrrev_b32 v16, 2, v2
  buffer_store_dword v0, v16, s[56:59], s65 offen sc1
  s_lshr_b32 s65, s85, 4
  s_lshl_b32 s65, s65, 14
  s_and_b32 s66, s85, 15
  s_lshl_b32 s66, s66, 4
  s_add_u32 s42, s65, s66
  s_waitcnt vmcnt(15)
  s_barrier
  s_mov_b32 m0, s17
  s_mov_b32 s8, s18
  s_mov_b32 s9, s19
  s_mov_b32 s10, 2097152
  s_mov_b32 s11, 0x00020000
  s_lshl_b32 s65, s85, 10
  buffer_load_dwordx4 v2, s[8:11], s65 offen lds
  s_mov_b32 s8, s22
  s_mov_b32 s9, s23
  s_mov_b32 s10, 4194304
  s_mov_b32 s11, 0x00020000
  s_lshl_b32 s65, s85, 10
  buffer_load_dwordx4 v2, s[8:11], s65 offen lds
  s_add_u32 s65, s65, 2097152
  buffer_load_dwordx4 v2, s[8:11], s65 offen lds
  s_mov_b32 s8, s24
  s_mov_b32 s9, s25
  s_mov_b32 s10, 4194304
  s_mov_b32 s11, 0x00020000
  s_lshl_b32 s65, s85, 10
  buffer_load_dwordx4 v2, s[8:11], s65 offen lds
  s_add_u32 s65, s65, 2097152
  buffer_load_dwordx4 v2, s[8:11], s65 offen lds
  ds_read_b128 v[32:35], v3 offset:0
  ds_read_b128 v[36:39], v3 offset:1024
  ds_read_b64_tr_b16 v[64:65], v5 offset:0
  ds_read_b64_tr_b16 v[66:67], v5 offset:2048
  ds_read_b128 v[40:43], v3 offset:2048
  ds_read_b64_tr_b16 v[68:69], v6 offset:0
  ds_read_b64_tr_b16 v[70:71], v6 offset:2048
  ds_read_b64_tr_b16 v[72:73], v5 offset:1024
  ds_read_b64_tr_b16 v[74:75], v5 offset:3072
  ds_read_b128 v[44:47], v3 offset:3072
  ds_read_b64_tr_b16 v[76:77], v6 offset:1024
  ds_read_b64_tr_b16 v[78:79], v6 offset:3072
  ds_read_b128 v[48:51], v3 offset:4096
  ds_read_b128 v[52:55], v3 offset:5120
  ds_read_b128 v[56:59], v3 offset:6144
  ds_read_b128 v[60:63], v3 offset:7168
  s_waitcnt lgkmcnt(4)
  v_mfma_f32_16x16x32_bf16 v[128:131], v[64:67], v[32:35], v[128:131]
  v_lshlrev_b32 v100, 16, v96
  v_mfma_f32_16x16x32_bf16 v[132:135], v[68:71], v[32:35], v[132:135]
  v_and_b32 v101, 0xffff0000, v96
  v_mfma_f32_16x16x32_bf16 v[136:139], v[32:35], v[72:75], v[136:139]
  v_lshlrev_b32 v102, 16, v97
  v_mfma_f32_16x16x32_bf16 v[140:143], v[32:35], v[76:79], v[140:143]
  v_and_b32 v103, 0xffff0000, v97
  v_mfma_f32_16x16x32_bf16 v[144:147], v[64:67], v[36:39], v[144:147]
  v_lshlrev_b32 v104, 16, v98
  v_mfma_f32_16x16x32_bf16 v[148:151], v[68:71], v[36:39], v[148:151]
  v_and_b32 v105, 0xffff0000, v98
  v_mfma_f32_16x16x32_bf16 v[152:155], v[36:39], v[72:75], v[152:155]
  v_lshlrev_b32 v106, 16, v99
  v_mfma_f32_16x16x32_bf16 v[156:159], v[36:39], v[76:79], v[156:159]
  s_waitcnt vmcnt(16) lgkmcnt(0)
  s_barrier
  v_mfma_f32_16x16x32_bf16 v[160:163], v[64:67], v[40:43], v[160:163]
  ds_read_b128 v[32:35], v3 offset:32768
  v_and_b32 v107, 0xffff0000, v99
  v_mfma_f32_16x16x32_bf16 v[164:167], v[68:71], v[40:43], v[164:167]
  ds_read_b128 v[36:39], v3 offset:33792
  v_add_f32 v108, v100, v101
  v_mfma_f32_16x16x32_bf16 v[168:171], v[40:43], v[72:75], v[168:171]
  ds_read_b64_tr_b16 v[80:81], v5 offset:32768
  v_add_f32 v108, v108, v102
  v_mfma_f32_16x16x32_bf16 v[172:175], v[40:43], v[76:79], v[172:175]
  ds_read_b64_tr_b16 v[82:83], v5 offset:34816
  ds_read_b128 v[40:43], v3 offset:34816
  v_mfma_f32_16x16x32_bf16 v[176:179], v[64:67], v[44:47], v[176:179]
  ds_read_b64_tr_b16 v[84:85], v6 offset:32768
  s_add_u32 m0, s28, 0
  s_add_u32 s65, s68, 0
  buffer_load_dwordx4 v7, s[44:47], s65 offen lds
  v_mfma_f32_16x16x32_bf16 v[180:183], v[68:71], v[44:47], v[180:183]
  ds_read_b64_tr_b16 v[86:87], v6 offset:34816
  v_add_f32 v108, v108, v103
  v_mfma_f32_16x16x32_bf16 v[184:187], v[44:47], v[72:75], v[184:187]
  ds_read_b64_tr_b16 v[88:89], v5 offset:33792
  v_add_f32 v108, v108, v104
  v_mfma_f32_16x16x32_bf16 v[188:191], v[44:47], v[76:79], v[188:191]
  ds_read_b64_tr_b16 v[90:91], v5 offset:35840
  ds_read_b128 v[44:47], v3 offset:35840
  v_mfma_f32_16x16x32_bf16 v[192:195], v[64:67], v[48:51], v[192:195]
  ds_read_b64_tr_b16 v[92:93], v6 offset:33792
  v_add_f32 v108, v108, v105
  v_mfma_f32_16x16x32_bf16 v[196:199], v[68:71], v[48:51], v[196:199]
  ds_read_b64_tr_b16 v[94:95], v6 offset:35840
  v_add_f32 v108, v108, v106
  v_mfma_f32_16x16x32_bf16 v[200:203], v[48:51], v[72:75], v[200:203]
  s_add_u32 m0, s28, 1024
  s_add_u32 s65, s68, 16384
  buffer_load_dwordx4 v7, s[44:47], s65 offen lds
  v_mfma_f32_16x16x32_bf16 v[204:207], v[48:51], v[76:79], v[204:207]
  ds_read_b128 v[48:51], v3 offset:36864
  v_add_f32 v108, v108, v107
  v_mfma_f32_16x16x32_bf16 v[208:211], v[64:67], v[52:55], v[208:211]
  s_nop 0
  v_add_f32_dpp v108, v108, v108 quad_perm:[1,0,3,2] row_mask:0xf bank_mask:0xf
  v_mfma_f32_16x16x32_bf16 v[212:215], v[68:71], v[52:55], v[212:215]
  s_nop 0
  v_add_f32_dpp v108, v108, v108 quad_perm:[2,3,0,1] row_mask:0xf bank_mask:0xf
  v_mfma_f32_16x16x32_bf16 v[216:219], v[52:55], v[72:75], v[216:219]
  s_nop 0
  v_add_f32_dpp v108, v108, v108 row_half_mirror row_mask:0xf bank_mask:0xf
  v_mfma_f32_16x16x32_bf16 v[220:223], v[52:55], v[76:79], v[220:223]
  ds_read_b128 v[52:55], v3 offset:37888
  s_nop 0
  v_add_f32_dpp v108, v108, v108 row_mirror row_mask:0xf bank_mask:0xf
  v_mfma_f32_16x16x32_bf16 v[224:227], v[64:67], v[56:59], v[224:227]
  s_add_u32 m0, s28, 16384
  s_nop 0
  buffer_load_dwordx4 v9, s[48:51], s69 offen lds
  v_mfma_f32_16x16x32_bf16 v[228:231], v[68:71], v[56:59], v[228:231]
  v_mov_b32 v109, v108
  v_mfma_f32_16x16x32_bf16 v[232:235], v[56:59], v[72:75], v[232:235]
  s_nop 0
  v_permlane16_swap_b32 v108, v109
  v_mfma_f32_16x16x32_bf16 v[236:239], v[56:59], v[76:79], v[236:239]
  ds_read_b128 v[56:59], v3 offset:38912
  v_add_f32 v108, v108, v109
  v_mfma_f32_16x16x32_bf16 v[240:243], v[64:67], v[60:63], v[240:243]
  v_mov_b32 v109, v108
  v_mfma_f32_16x16x32_bf16 v[244:247], v[68:71], v[60:63], v[244:247]
  s_nop 0
  v_permlane32_swap_b32 v108, v109
  v_mfma_f32_16x16x32_bf16 v[248:251], v[60:63], v[72:75], v[248:251]
  s_add_u32 m0, s28, 17408
  s_nop 0
  buffer_load_dwordx4 v9, s[52:55], s69 offen lds
  s_add_u32 s68, s68, 64
  s_add_u32 s69, s69, 262144
  s_add_u32 s28, s28, 32768
  s_and_b32 s28, s28, 0x1ffff
  v_mfma_f32_16x16x32_bf16 v[252:255], v[60:63], v[76:79], v[252:255]
  ds_read_b128 v[60:63], v3 offset:39936
  v_add_f32 v108, v108, v109
  s_waitcnt lgkmcnt(4)
  v_mfma_f32_16x16x32_bf16 v[128:131], v[80:83], v[32:35], v[128:131]
  v_mul_f32 v110, 0x3b000000, v108
  v_mfma_f32_16x16x32_bf16 v[132:135], v[84:87], v[32:35], v[132:135]
  v_sub_f32 v109, v100, v110
  v_mfma_f32_16x16x32_bf16 v[136:139], v[32:35], v[88:91], v[136:139]
  v_mul_f32 v108, v109, v109
  v_mfma_f32_16x16x32_bf16 v[140:143], v[32:35], v[92:95], v[140:143]
  v_xor_b32 v3, 65536, v3
  v_xor_b32 v5, 65536, v5
  v_xor_b32 v6, 65536, v6
  v_mfma_f32_16x16x32_bf16 v[144:147], v[80:83], v[36:39], v[144:147]
  v_sub_f32 v109, v101, v110
  v_mfma_f32_16x16x32_bf16 v[148:151], v[84:87], v[36:39], v[148:151]
  v_fmac_f32 v108, v109, v109
  v_mfma_f32_16x16x32_bf16 v[152:155], v[36:39], v[88:91], v[152:155]
  v_sub_f32 v109, v102, v110
  v_mfma_f32_16x16x32_bf16 v[156:159], v[36:39], v[92:95], v[156:159]
  s_waitcnt vmcnt(16) lgkmcnt(0)
  s_barrier
  v_mfma_f32_16x16x32_bf16 v[160:163], v[80:83], v[40:43], v[160:163]
  ds_read_b128 v[32:35], v3 offset:0
  v_fmac_f32 v108, v109, v109
  v_mfma_f32_16x16x32_bf16 v[164:167], v[84:87], v[40:43], v[164:167]
  ds_read_b128 v[36:39], v3 offset:1024
  v_sub_f32 v109, v103, v110
  v_mfma_f32_16x16x32_bf16 v[168:171], v[40:43], v[88:91], v[168:171]
  ds_read_b64_tr_b16 v[64:65], v5 offset:0
  v_fmac_f32 v108, v109, v109
  v_mfma_f32_16x16x32_bf16 v[172:175], v[40:43], v[92:95], v[172:175]
  ds_read_b64_tr_b16 v[66:67], v5 offset:2048
  ds_read_b128 v[40:43], v3 offset:2048
  v_mfma_f32_16x16x32_bf16 v[176:179], v[80:83], v[44:47], v[176:179]
  ds_read_b64_tr_b16 v[68:69], v6 offset:0
  s_add_u32 m0, s28, 0
  s_add_u32 s65, s68, 0
  buffer_load_dwordx4 v7, s[44:47], s65 offen lds
  v_mfma_f32_16x16x32_bf16 v[180:183], v[84:87], v[44:47], v[180:183]
  ds_read_b64_tr_b16 v[70:71], v6 offset:2048
  v_sub_f32 v109, v104, v110
  v_mfma_f32_16x16x32_bf16 v[184:187], v[44:47], v[88:91], v[184:187]
  ds_read_b64_tr_b16 v[72:73], v5 offset:1024
  v_fmac_f32 v108, v109, v109
  v_mfma_f32_16x16x32_bf16 v[188:191], v[44:47], v[92:95], v[188:191]
  ds_read_b64_tr_b16 v[74:75], v5 offset:3072
  ds_read_b128 v[44:47], v3 offset:3072
  v_mfma_f32_16x16x32_bf16 v[192:195], v[80:83], v[48:51], v[192:195]
  ds_read_b64_tr_b16 v[76:77], v6 offset:1024
  v_sub_f32 v109, v105, v110
  v_mfma_f32_16x16x32_bf16 v[196:199], v[84:87], v[48:51], v[196:199]
  ds_read_b64_tr_b16 v[78:79], v6 offset:3072
  v_fmac_f32 v108, v109, v109
  v_mfma_f32_16x16x32_bf16 v[200:203], v[48:51], v[88:91], v[200:203]
  s_add_u32 m0, s28, 1024
  s_add_u32 s65, s68, 16384
  buffer_load_dwordx4 v7, s[44:47], s65 offen lds
  v_mfma_f32_16x16x32_bf16 v[204:207], v[48:51], v[92:95], v[204:207]
  ds_read_b128 v[48:51], v3 offset:4096
  v_sub_f32 v109, v106, v110
  v_mfma_f32_16x16x32_bf16 v[208:211], v[80:83], v[52:55], v[208:211]
  v_fmac_f32 v108, v109, v109
  v_mfma_f32_16x16x32_bf16 v[212:215], v[84:87], v[52:55], v[212:215]
  v_sub_f32 v109, v107, v110
  v_mfma_f32_16x16x32_bf16 v[216:219], v[52:55], v[88:91], v[216:219]
  v_fmac_f32 v108, v109, v109
  v_mfma_f32_16x16x32_bf16 v[220:223], v[52:55], v[92:95], v[220:223]
  ds_read_b128 v[52:55], v3 offset:5120
  s_nop 0
  v_add_f32_dpp v108, v108, v108 quad_perm:[1,0,3,2] row_mask:0xf bank_mask:0xf
  v_mfma_f32_16x16x32_bf16 v[224:227], v[80:83], v[56:59], v[224:227]
  s_add_u32 m0, s28, 16384
  s_nop 0
  buffer_load_dwordx4 v9, s[48:51], s69 offen lds
  v_mfma_f32_16x16x32_bf16 v[228:231], v[84:87], v[56:59], v[228:231]
  s_nop 0
  v_add_f32_dpp v108, v108, v108 quad_perm:[2,3,0,1] row_mask:0xf bank_mask:0xf
  v_mfma_f32_16x16x32_bf16 v[232:235], v[56:59], v[88:91], v[232:235]
  s_nop 0
  v_add_f32_dpp v108, v108, v108 row_half_mirror row_mask:0xf bank_mask:0xf
  v_mfma_f32_16x16x32_bf16 v[236:239], v[56:59], v[92:95], v[236:239]
  ds_read_b128 v[56:59], v3 offset:6144
  s_nop 0
  v_add_f32_dpp v108, v108, v108 row_mirror row_mask:0xf bank_mask:0xf
  v_mfma_f32_16x16x32_bf16 v[240:243], v[80:83], v[60:63], v[240:243]
  v_mov_b32 v109, v108
  v_mfma_f32_16x16x32_bf16 v[244:247], v[84:87], v[60:63], v[244:247]
  s_nop 0
  v_permlane16_swap_b32 v108, v109
  v_mfma_f32_16x16x32_bf16 v[248:251], v[60:63], v[88:91], v[248:251]
  s_add_u32 m0, s28, 17408
  s_nop 0
  buffer_load_dwordx4 v9, s[52:55], s69 offen lds
  s_add_u32 s68, s68, 64
  s_add_u32 s69, s69, 262144
  s_add_u32 s28, s28, 32768
  s_and_b32 s28, s28, 0x1ffff
  v_mfma_f32_16x16x32_bf16 v[252:255], v[60:63], v[92:95], v[252:255]
  ds_read_b128 v[60:63], v3 offset:7168
  v_add_f32 v108, v108, v109
  s_waitcnt lgkmcnt(4)
  v_mfma_f32_16x16x32_bf16 v[128:131], v[64:67], v[32:35], v[128:131]
  v_mov_b32 v109, v108
  v_mfma_f32_16x16x32_bf16 v[132:135], v[68:71], v[32:35], v[132:135]
  s_nop 0
  v_permlane32_swap_b32 v108, v109
  v_mfma_f32_16x16x32_bf16 v[136:139], v[32:35], v[72:75], v[136:139]
  v_add_f32 v108, v108, v109
  v_mfma_f32_16x16x32_bf16 v[140:143], v[32:35], v[76:79], v[140:143]
  v_mul_f32 v108, 0x3b000000, v108
  v_mfma_f32_16x16x32_bf16 v[144:147], v[64:67], v[36:39], v[144:147]
  v_cvt_pk_bf16_f32 v110, v110, v110
  v_mfma_f32_16x16x32_bf16 v[148:151], v[68:71], v[36:39], v[148:151]
  v_lshlrev_b32 v110, 16, v110
  v_mfma_f32_16x16x32_bf16 v[152:155], v[36:39], v[72:75], v[152:155]
  v_cvt_pk_bf16_f32 v108, v108, v108
  v_mfma_f32_16x16x32_bf16 v[156:159], v[36:39], v[76:79], v[156:159]
  s_waitcnt vmcnt(16) lgkmcnt(0)
  s_barrier
  v_mfma_f32_16x16x32_bf16 v[160:163], v[64:67], v[40:43], v[160:163]
  ds_read_b128 v[32:35], v3 offset:32768
  v_lshlrev_b32 v108, 16, v108
  v_mfma_f32_16x16x32_bf16 v[164:167], v[68:71], v[40:43], v[164:167]
  ds_read_b128 v[36:39], v3 offset:33792
  v_add_f32 v108, 0x3727c5ac, v108
  v_mfma_f32_16x16x32_bf16 v[168:171], v[40:43], v[72:75], v[168:171]
  ds_read_b64_tr_b16 v[80:81], v5 offset:32768
  v_cvt_pk_bf16_f32 v108, v108, v108
  v_mfma_f32_16x16x32_bf16 v[172:175], v[40:43], v[76:79], v[172:175]
  ds_read_b64_tr_b16 v[82:83], v5 offset:34816
  ds_read_b128 v[40:43], v3 offset:34816
  v_mfma_f32_16x16x32_bf16 v[176:179], v[64:67], v[44:47], v[176:179]
  ds_read_b64_tr_b16 v[84:85], v6 offset:32768
  s_add_u32 m0, s28, 0
  s_add_u32 s65, s68, 0
  buffer_load_dwordx4 v7, s[44:47], s65 offen lds
  v_mfma_f32_16x16x32_bf16 v[180:183], v[68:71], v[44:47], v[180:183]
  ds_read_b64_tr_b16 v[86:87], v6 offset:34816
  v_lshlrev_b32 v108, 16, v108
  v_mfma_f32_16x16x32_bf16 v[184:187], v[44:47], v[72:75], v[184:187]
  ds_read_b64_tr_b16 v[88:89], v5 offset:33792
  v_sqrt_f32 v108, v108
  v_mfma_f32_16x16x32_bf16 v[188:191], v[44:47], v[76:79], v[188:191]
  ds_read_b64_tr_b16 v[90:91], v5 offset:35840
  ds_read_b128 v[44:47], v3 offset:35840
  v_mfma_f32_16x16x32_bf16 v[192:195], v[64:67], v[48:51], v[192:195]
  ds_read_b64_tr_b16 v[92:93], v6 offset:33792
  v_cvt_pk_bf16_f32 v108, v108, v108
  v_mfma_f32_16x16x32_bf16 v[196:199], v[68:71], v[48:51], v[196:199]
  ds_read_b64_tr_b16 v[94:95], v6 offset:35840
  v_lshlrev_b32 v108, 16, v108
  v_mfma_f32_16x16x32_bf16 v[200:203], v[48:51], v[72:75], v[200:203]
  s_add_u32 m0, s28, 1024
  s_add_u32 s65, s68, 16384
  buffer_load_dwordx4 v7, s[44:47], s65 offen lds
  v_mfma_f32_16x16x32_bf16 v[204:207], v[48:51], v[76:79], v[204:207]
  ds_read_b128 v[48:51], v3 offset:36864
  v_rcp_f32 v111, v108
  v_mfma_f32_16x16x32_bf16 v[208:211], v[64:67], v[52:55], v[208:211]
  v_sub_f32 v100, v100, v110
  v_mfma_f32_16x16x32_bf16 v[212:215], v[68:71], v[52:55], v[212:215]
  v_cvt_pk_bf16_f32 v100, v100, v100
  v_mfma_f32_16x16x32_bf16 v[216:219], v[52:55], v[72:75], v[216:219]
  v_lshlrev_b32 v100, 16, v100
  v_mfma_f32_16x16x32_bf16 v[220:223], v[52:55], v[76:79], v[220:223]
  ds_read_b128 v[52:55], v3 offset:37888
  v_sub_f32 v101, v101, v110
  v_mfma_f32_16x16x32_bf16 v[224:227], v[64:67], v[56:59], v[224:227]
  s_add_u32 m0, s28, 16384
  s_nop 0
  buffer_load_dwordx4 v9, s[48:51], s69 offen lds
  v_mfma_f32_16x16x32_bf16 v[228:231], v[68:71], v[56:59], v[228:231]
  v_cvt_pk_bf16_f32 v101, v101, v101
  v_mfma_f32_16x16x32_bf16 v[232:235], v[56:59], v[72:75], v[232:235]
  v_lshlrev_b32 v101, 16, v101
  v_mfma_f32_16x16x32_bf16 v[236:239], v[56:59], v[76:79], v[236:239]
  ds_read_b128 v[56:59], v3 offset:38912
  v_sub_f32 v102, v102, v110
  v_mfma_f32_16x16x32_bf16 v[240:243], v[64:67], v[60:63], v[240:243]
  v_cvt_pk_bf16_f32 v102, v102, v102
  v_mfma_f32_16x16x32_bf16 v[244:247], v[68:71], v[60:63], v[244:247]
  v_lshlrev_b32 v102, 16, v102
  v_mfma_f32_16x16x32_bf16 v[248:251], v[60:63], v[72:75], v[248:251]
  s_add_u32 m0, s28, 17408
  s_nop 0
  buffer_load_dwordx4 v9, s[52:55], s69 offen lds
  s_add_u32 s68, s68, 64
  s_add_u32 s69, s69, 262144
  s_add_u32 s28, s28, 32768
  s_and_b32 s28, s28, 0x1ffff
  v_mfma_f32_16x16x32_bf16 v[252:255], v[60:63], v[76:79], v[252:255]
  ds_read_b128 v[60:63], v3 offset:39936
  v_sub_f32 v103, v103, v110
  s_waitcnt lgkmcnt(4)
  v_mfma_f32_16x16x32_bf16 v[128:131], v[80:83], v[32:35], v[128:131]
  v_cvt_pk_bf16_f32 v103, v103, v103
  v_mfma_f32_16x16x32_bf16 v[132:135], v[84:87], v[32:35], v[132:135]
  v_lshlrev_b32 v103, 16, v103
  v_mfma_f32_16x16x32_bf16 v[136:139], v[32:35], v[88:91], v[136:139]
  v_sub_f32 v104, v104, v110
  v_mfma_f32_16x16x32_bf16 v[140:143], v[32:35], v[92:95], v[140:143]
  v_xor_b32 v3, 65536, v3
  v_xor_b32 v5, 65536, v5
  v_xor_b32 v6, 65536, v6
  v_mfma_f32_16x16x32_bf16 v[144:147], v[80:83], v[36:39], v[144:147]
  v_cvt_pk_bf16_f32 v104, v104, v104
  v_mfma_f32_16x16x32_bf16 v[148:151], v[84:87], v[36:39], v[148:151]
  v_lshlrev_b32 v104, 16, v104
  v_mfma_f32_16x16x32_bf16 v[152:155], v[36:39], v[88:91], v[152:155]
  v_sub_f32 v105, v105, v110
  v_mfma_f32_16x16x32_bf16 v[156:159], v[36:39], v[92:95], v[156:159]
  s_waitcnt vmcnt(8) lgkmcnt(0)
  s_barrier
  v_mfma_f32_16x16x32_bf16 v[160:163], v[80:83], v[40:43], v[160:163]
  ds_read_b128 v[32:35], v3 offset:0
  v_cvt_pk_bf16_f32 v105, v105, v105
  v_mfma_f32_16x16x32_bf16 v[164:167], v[84:87], v[40:43], v[164:167]
  ds_read_b128 v[36:39], v3 offset:1024
  v_lshlrev_b32 v105, 16, v105
  v_mfma_f32_16x16x32_bf16 v[168:171], v[40:43], v[88:91], v[168:171]
  ds_read_b64_tr_b16 v[64:65], v5 offset:0
  v_sub_f32 v106, v106, v110
  v_mfma_f32_16x16x32_bf16 v[172:175], v[40:43], v[92:95], v[172:175]
  ds_read_b64_tr_b16 v[66:67], v5 offset:2048
  ds_read_b128 v[40:43], v3 offset:2048
  v_mfma_f32_16x16x32_bf16 v[176:179], v[80:83], v[44:47], v[176:179]
  ds_read_b64_tr_b16 v[68:69], v6 offset:0
  s_add_u32 m0, s28, 0
  s_add_u32 s65, s68, 0
  buffer_load_dwordx4 v7, s[44:47], s65 offen lds
  v_mfma_f32_16x16x32_bf16 v[180:183], v[84:87], v[44:47], v[180:183]
  ds_read_b64_tr_b16 v[70:71], v6 offset:2048
  v_cvt_pk_bf16_f32 v106, v106, v106
  v_mfma_f32_16x16x32_bf16 v[184:187], v[44:47], v[88:91], v[184:187]
  ds_read_b64_tr_b16 v[72:73], v5 offset:1024
  v_lshlrev_b32 v106, 16, v106
  v_mfma_f32_16x16x32_bf16 v[188:191], v[44:47], v[92:95], v[188:191]
  ds_read_b64_tr_b16 v[74:75], v5 offset:3072
  ds_read_b128 v[44:47], v3 offset:3072
  v_mfma_f32_16x16x32_bf16 v[192:195], v[80:83], v[48:51], v[192:195]
  ds_read_b64_tr_b16 v[76:77], v6 offset:1024
  v_sub_f32 v107, v107, v110
  v_mfma_f32_16x16x32_bf16 v[196:199], v[84:87], v[48:51], v[196:199]
  ds_read_b64_tr_b16 v[78:79], v6 offset:3072
  v_cvt_pk_bf16_f32 v107, v107, v107
  v_mfma_f32_16x16x32_bf16 v[200:203], v[48:51], v[88:91], v[200:203]
  s_add_u32 m0, s28, 1024
  s_add_u32 s65, s68, 16384
  buffer_load_dwordx4 v7, s[44:47], s65 offen lds
  v_mfma_f32_16x16x32_bf16 v[204:207], v[48:51], v[92:95], v[204:207]
  ds_read_b128 v[48:51], v3 offset:4096
  v_lshlrev_b32 v107, 16, v107
  v_mfma_f32_16x16x32_bf16 v[208:211], v[80:83], v[52:55], v[208:211]
  v_mul_f32 v109, v100, v111
  v_mfma_f32_16x16x32_bf16 v[212:215], v[84:87], v[52:55], v[212:215]
  v_fma_f32 v112, -v109, v108, v100
  v_mfma_f32_16x16x32_bf16 v[216:219], v[52:55], v[88:91], v[216:219]
  v_fma_f32 v100, v112, v111, v109
  v_mfma_f32_16x16x32_bf16 v[220:223], v[52:55], v[92:95], v[220:223]
  ds_read_b128 v[52:55], v3 offset:5120
  v_mul_f32 v109, v101, v111
  v_mfma_f32_16x16x32_bf16 v[224:227], v[80:83], v[56:59], v[224:227]
  s_add_u32 m0, s28, 16384
  s_nop 0
  buffer_load_dwordx4 v9, s[48:51], s69 offen lds
  v_mfma_f32_16x16x32_bf16 v[228:231], v[84:87], v[56:59], v[228:231]
  v_fma_f32 v112, -v109, v108, v101
  v_mfma_f32_16x16x32_bf16 v[232:235], v[56:59], v[88:91], v[232:235]
  v_fma_f32 v101, v112, v111, v109
  v_mfma_f32_16x16x32_bf16 v[236:239], v[56:59], v[92:95], v[236:239]
  ds_read_b128 v[56:59], v3 offset:6144
  v_mul_f32 v109, v102, v111
  v_mfma_f32_16x16x32_bf16 v[240:243], v[80:83], v[60:63], v[240:243]
  v_fma_f32 v112, -v109, v108, v102
  v_mfma_f32_16x16x32_bf16 v[244:247], v[84:87], v[60:63], v[244:247]
  v_fma_f32 v102, v112, v111, v109
  v_mfma_f32_16x16x32_bf16 v[248:251], v[60:63], v[88:91], v[248:251]
  s_add_u32 m0, s28, 17408
  s_nop 0
  buffer_load_dwordx4 v9, s[52:55], s69 offen lds
  s_add_u32 s68, s68, 64
  s_add_u32 s69, s69, 262144
  s_add_u32 s28, s28, 32768
  s_and_b32 s28, s28, 0x1ffff
  v_mfma_f32_16x16x32_bf16 v[252:255], v[60:63], v[92:95], v[252:255]
  ds_read_b128 v[60:63], v3 offset:7168
  v_mul_f32 v109, v103, v111
  s_waitcnt lgkmcnt(4)
  v_mfma_f32_16x16x32_bf16 v[128:131], v[64:67], v[32:35], v[128:131]
  v_fma_f32 v112, -v109, v108, v103
  v_mfma_f32_16x16x32_bf16 v[132:135], v[68:71], v[32:35], v[132:135]
  v_fma_f32 v103, v112, v111, v109
  v_mfma_f32_16x16x32_bf16 v[136:139], v[32:35], v[72:75], v[136:139]
  v_mul_f32 v109, v104, v111
  v_mfma_f32_16x16x32_bf16 v[140:143], v[32:35], v[76:79], v[140:143]
  v_fma_f32 v112, -v109, v108, v104
  v_mfma_f32_16x16x32_bf16 v[144:147], v[64:67], v[36:39], v[144:147]
  v_fma_f32 v104, v112, v111, v109
  v_mfma_f32_16x16x32_bf16 v[148:151], v[68:71], v[36:39], v[148:151]
  v_mul_f32 v109, v105, v111
  v_mfma_f32_16x16x32_bf16 v[152:155], v[36:39], v[72:75], v[152:155]
  v_fma_f32 v112, -v109, v108, v105
  v_mfma_f32_16x16x32_bf16 v[156:159], v[36:39], v[76:79], v[156:159]
  s_waitcnt vmcnt(8) lgkmcnt(0)
  s_barrier
  v_mfma_f32_16x16x32_bf16 v[160:163], v[64:67], v[40:43], v[160:163]
  ds_read_b128 v[32:35], v3 offset:32768
  v_fma_f32 v105, v112, v111, v109
  v_mfma_f32_16x16x32_bf16 v[164:167], v[68:71], v[40:43], v[164:167]
  ds_read_b128 v[36:39], v3 offset:33792
  v_mul_f32 v109, v106, v111
  v_mfma_f32_16x16x32_bf16 v[168:171], v[40:43], v[72:75], v[168:171]
  s_mov_b32 m0, s17
  s_mov_b32 s8, s20
  s_mov_b32 s9, s21
  s_mov_b32 s10, 4194304
  s_mov_b32 s11, 0x00020000
  s_lshl_b32 s65, s85, 10
  buffer_load_dwordx4 v2, s[8:11], s65 offen lds
  s_add_u32 s65, s65, 2097152
  buffer_load_dwordx4 v2, s[8:11], s65 offen lds
  ds_read_b64_tr_b16 v[80:81], v5 offset:32768
  v_mfma_f32_16x16x32_bf16 v[172:175], v[40:43], v[76:79], v[172:175]
  ds_read_b64_tr_b16 v[82:83], v5 offset:34816
  ds_read_b128 v[40:43], v3 offset:34816
  v_mfma_f32_16x16x32_bf16 v[176:179], v[64:67], v[44:47], v[176:179]
  ds_read_b64_tr_b16 v[84:85], v6 offset:32768
  s_add_u32 m0, s28, 0
  s_add_u32 s65, s68, 0
  buffer_load_dwordx4 v7, s[44:47], s65 offen lds
  v_mfma_f32_16x16x32_bf16 v[180:183], v[68:71], v[44:47], v[180:183]
  ds_read_b64_tr_b16 v[86:87], v6 offset:34816
  v_fma_f32 v112, -v109, v108, v106
  v_mfma_f32_16x16x32_bf16 v[184:187], v[44:47], v[72:75], v[184:187]
  ds_read_b64_tr_b16 v[88:89], v5 offset:33792
  v_fma_f32 v106, v112, v111, v109
  v_mfma_f32_16x16x32_bf16 v[188:191], v[44:47], v[76:79], v[188:191]
  ds_read_b64_tr_b16 v[90:91], v5 offset:35840
  ds_read_b128 v[44:47], v3 offset:35840
  v_mfma_f32_16x16x32_bf16 v[192:195], v[64:67], v[48:51], v[192:195]
  ds_read_b64_tr_b16 v[92:93], v6 offset:33792
  v_mul_f32 v109, v107, v111
  v_mfma_f32_16x16x32_bf16 v[196:199], v[68:71], v[48:51], v[196:199]
  ds_read_b64_tr_b16 v[94:95], v6 offset:35840
  v_fma_f32 v112, -v109, v108, v107
  v_mfma_f32_16x16x32_bf16 v[200:203], v[48:51], v[72:75], v[200:203]
  s_add_u32 m0, s28, 1024
  s_add_u32 s65, s68, 16384
  buffer_load_dwordx4 v7, s[44:47], s65 offen lds
  v_mfma_f32_16x16x32_bf16 v[204:207], v[48:51], v[76:79], v[204:207]
  ds_read_b128 v[48:51], v3 offset:36864
  v_fma_f32 v107, v112, v111, v109
  v_mfma_f32_16x16x32_bf16 v[208:211], v[64:67], v[52:55], v[208:211]
  v_cvt_pk_bf16_f32 v96, v100, v101
  v_mfma_f32_16x16x32_bf16 v[212:215], v[68:71], v[52:55], v[212:215]
  v_cvt_pk_bf16_f32 v97, v102, v103
  v_mfma_f32_16x16x32_bf16 v[216:219], v[52:55], v[72:75], v[216:219]
  v_cvt_pk_bf16_f32 v98, v104, v105
  v_mfma_f32_16x16x32_bf16 v[220:223], v[52:55], v[76:79], v[220:223]
  ds_read_b128 v[52:55], v3 offset:37888
  v_cvt_pk_bf16_f32 v99, v106, v107
  v_mfma_f32_16x16x32_bf16 v[224:227], v[64:67], v[56:59], v[224:227]
  s_add_u32 m0, s28, 16384
  s_nop 0
  buffer_load_dwordx4 v9, s[48:51], s69 offen lds
  v_mfma_f32_16x16x32_bf16 v[228:231], v[68:71], v[56:59], v[228:231]
  buffer_store_dwordx4 v[96:99], v30, s[56:59], s42 offen sc1
  v_mfma_f32_16x16x32_bf16 v[232:235], v[56:59], v[72:75], v[232:235]
  v_mfma_f32_16x16x32_bf16 v[236:239], v[56:59], v[76:79], v[236:239]
  ds_read_b128 v[56:59], v3 offset:38912
  v_mfma_f32_16x16x32_bf16 v[240:243], v[64:67], v[60:63], v[240:243]
  v_mfma_f32_16x16x32_bf16 v[244:247], v[68:71], v[60:63], v[244:247]
  v_mfma_f32_16x16x32_bf16 v[248:251], v[60:63], v[72:75], v[248:251]
  s_add_u32 m0, s28, 17408
  s_nop 0
  buffer_load_dwordx4 v9, s[52:55], s69 offen lds
  s_add_u32 s68, s68, 64
  s_add_u32 s69, s69, 262144
  s_add_u32 s28, s28, 32768
  s_and_b32 s28, s28, 0x1ffff
  v_mfma_f32_16x16x32_bf16 v[252:255], v[60:63], v[76:79], v[252:255]
  ds_read_b128 v[60:63], v3 offset:39936
  s_waitcnt lgkmcnt(4)
  v_mfma_f32_16x16x32_bf16 v[128:131], v[80:83], v[32:35], v[128:131]
  v_mfma_f32_16x16x32_bf16 v[132:135], v[84:87], v[32:35], v[132:135]
  v_mfma_f32_16x16x32_bf16 v[136:139], v[32:35], v[88:91], v[136:139]
  v_mfma_f32_16x16x32_bf16 v[140:143], v[32:35], v[92:95], v[140:143]
  v_xor_b32 v3, 65536, v3
  v_xor_b32 v5, 65536, v5
  v_xor_b32 v6, 65536, v6
  v_mfma_f32_16x16x32_bf16 v[144:147], v[80:83], v[36:39], v[144:147]
  v_mfma_f32_16x16x32_bf16 v[148:151], v[84:87], v[36:39], v[148:151]
  v_mfma_f32_16x16x32_bf16 v[152:155], v[36:39], v[88:91], v[152:155]
  v_mfma_f32_16x16x32_bf16 v[156:159], v[36:39], v[92:95], v[156:159]
  s_waitcnt vmcnt(11) lgkmcnt(0)
  s_barrier
  v_mfma_f32_16x16x32_bf16 v[160:163], v[80:83], v[40:43], v[160:163]
  ds_read_b128 v[32:35], v3 offset:0
  v_mfma_f32_16x16x32_bf16 v[164:167], v[84:87], v[40:43], v[164:167]
  ds_read_b128 v[36:39], v3 offset:1024
  v_mfma_f32_16x16x32_bf16 v[168:171], v[40:43], v[88:91], v[168:171]
  ds_read_b64_tr_b16 v[64:65], v5 offset:0
  v_mfma_f32_16x16x32_bf16 v[172:175], v[40:43], v[92:95], v[172:175]
  ds_read_b64_tr_b16 v[66:67], v5 offset:2048
  ds_read_b128 v[40:43], v3 offset:2048
  v_mfma_f32_16x16x32_bf16 v[176:179], v[80:83], v[44:47], v[176:179]
  ds_read_b64_tr_b16 v[68:69], v6 offset:0
  s_add_u32 m0, s28, 0
  s_add_u32 s65, s68, 0
  buffer_load_dwordx4 v7, s[44:47], s65 offen lds
  v_mfma_f32_16x16x32_bf16 v[180:183], v[84:87], v[44:47], v[180:183]
  ds_read_b64_tr_b16 v[70:71], v6 offset:2048
  v_mfma_f32_16x16x32_bf16 v[184:187], v[44:47], v[88:91], v[184:187]
  ds_read_b64_tr_b16 v[72:73], v5 offset:1024
  v_mfma_f32_16x16x32_bf16 v[188:191], v[44:47], v[92:95], v[188:191]
  ds_read_b64_tr_b16 v[74:75], v5 offset:3072
  ds_read_b128 v[44:47], v3 offset:3072
  v_mfma_f32_16x16x32_bf16 v[192:195], v[80:83], v[48:51], v[192:195]
  ds_read_b64_tr_b16 v[76:77], v6 offset:1024
  v_mfma_f32_16x16x32_bf16 v[196:199], v[84:87], v[48:51], v[196:199]
  ds_read_b64_tr_b16 v[78:79], v6 offset:3072
  v_mfma_f32_16x16x32_bf16 v[200:203], v[48:51], v[88:91], v[200:203]
  s_add_u32 m0, s28, 1024
  s_add_u32 s65, s68, 16384
  buffer_load_dwordx4 v7, s[44:47], s65 offen lds
  v_mfma_f32_16x16x32_bf16 v[204:207], v[48:51], v[92:95], v[204:207]
  ds_read_b128 v[48:51], v3 offset:4096
  v_mfma_f32_16x16x32_bf16 v[208:211], v[80:83], v[52:55], v[208:211]
  v_mfma_f32_16x16x32_bf16 v[212:215], v[84:87], v[52:55], v[212:215]
  v_mfma_f32_16x16x32_bf16 v[216:219], v[52:55], v[88:91], v[216:219]
  v_mfma_f32_16x16x32_bf16 v[220:223], v[52:55], v[92:95], v[220:223]
  ds_read_b128 v[52:55], v3 offset:5120
  v_mfma_f32_16x16x32_bf16 v[224:227], v[80:83], v[56:59], v[224:227]
  s_add_u32 m0, s28, 16384
  s_nop 0
  buffer_load_dwordx4 v9, s[48:51], s69 offen lds
  v_mfma_f32_16x16x32_bf16 v[228:231], v[84:87], v[56:59], v[228:231]
  v_mfma_f32_16x16x32_bf16 v[232:235], v[56:59], v[88:91], v[232:235]
  v_mfma_f32_16x16x32_bf16 v[236:239], v[56:59], v[92:95], v[236:239]
  ds_read_b128 v[56:59], v3 offset:6144
  v_mfma_f32_16x16x32_bf16 v[240:243], v[80:83], v[60:63], v[240:243]
  v_mfma_f32_16x16x32_bf16 v[244:247], v[84:87], v[60:63], v[244:247]
  v_mfma_f32_16x16x32_bf16 v[248:251], v[60:63], v[88:91], v[248:251]
  s_add_u32 m0, s28, 17408
  s_nop 0
  buffer_load_dwordx4 v9, s[52:55], s69 offen lds
  s_add_u32 s68, s68, 64
  s_add_u32 s69, s69, 262144
  s_add_u32 s28, s28, 32768
  s_and_b32 s28, s28, 0x1ffff
  v_mfma_f32_16x16x32_bf16 v[252:255], v[60:63], v[92:95], v[252:255]
  ds_read_b128 v[60:63], v3 offset:7168
  s_waitcnt lgkmcnt(4)
  v_mfma_f32_16x16x32_bf16 v[128:131], v[64:67], v[32:35], v[128:131]
  v_mfma_f32_16x16x32_bf16 v[132:135], v[68:71], v[32:35], v[132:135]
  v_mfma_f32_16x16x32_bf16 v[136:139], v[32:35], v[72:75], v[136:139]
  v_mfma_f32_16x16x32_bf16 v[140:143], v[32:35], v[76:79], v[140:143]
  v_mfma_f32_16x16x32_bf16 v[144:147], v[64:67], v[36:39], v[144:147]
  v_mfma_f32_16x16x32_bf16 v[148:151], v[68:71], v[36:39], v[148:151]
  v_mfma_f32_16x16x32_bf16 v[152:155], v[36:39], v[72:75], v[152:155]
  v_mfma_f32_16x16x32_bf16 v[156:159], v[36:39], v[76:79], v[156:159]
  s_waitcnt vmcnt(11) lgkmcnt(0)
  s_barrier
  v_mfma_f32_16x16x32_bf16 v[160:163], v[64:67], v[40:43], v[160:163]
  ds_read_b128 v[32:35], v3 offset:32768
  v_mfma_f32_16x16x32_bf16 v[164:167], v[68:71], v[40:43], v[164:167]
  ds_read_b128 v[36:39], v3 offset:33792
  v_mfma_f32_16x16x32_bf16 v[168:171], v[40:43], v[72:75], v[168:171]
  s_mov_b32 m0, s17
  s_mov_b32 s8, s30
  s_mov_b32 s9, s31
  s_mov_b32 s10, 1409024
  s_mov_b32 s11, 0x00020000
  s_lshl_b32 s65, s85, 10
  buffer_load_dwordx4 v2, s[8:11], s65 offen lds
  s_mov_b32 s8, s32
  s_mov_b32 s9, s33
  s_mov_b32 s10, 1409024
  s_mov_b32 s11, 0x00020000
  s_lshl_b32 s65, s85, 10
  buffer_load_dwordx4 v2, s[8:11], s65 offen lds
  ds_read_b64_tr_b16 v[80:81], v5 offset:32768
  v_mfma_f32_16x16x32_bf16 v[172:175], v[40:43], v[76:79], v[172:175]
  ds_read_b64_tr_b16 v[82:83], v5 offset:34816
  ds_read_b128 v[40:43], v3 offset:34816
  v_mfma_f32_16x16x32_bf16 v[176:179], v[64:67], v[44:47], v[176:179]
  ds_read_b64_tr_b16 v[84:85], v6 offset:32768
  s_add_u32 m0, s28, 0
  s_add_u32 s65, s68, 0
  buffer_load_dwordx4 v7, s[44:47], s65 offen lds
  v_mfma_f32_16x16x32_bf16 v[180:183], v[68:71], v[44:47], v[180:183]
  ds_read_b64_tr_b16 v[86:87], v6 offset:34816
  v_mfma_f32_16x16x32_bf16 v[184:187], v[44:47], v[72:75], v[184:187]
  ds_read_b64_tr_b16 v[88:89], v5 offset:33792
  v_mfma_f32_16x16x32_bf16 v[188:191], v[44:47], v[76:79], v[188:191]
  ds_read_b64_tr_b16 v[90:91], v5 offset:35840
  ds_read_b128 v[44:47], v3 offset:35840
  v_mfma_f32_16x16x32_bf16 v[192:195], v[64:67], v[48:51], v[192:195]
  ds_read_b64_tr_b16 v[92:93], v6 offset:33792
  v_mfma_f32_16x16x32_bf16 v[196:199], v[68:71], v[48:51], v[196:199]
  ds_read_b64_tr_b16 v[94:95], v6 offset:35840
  v_mfma_f32_16x16x32_bf16 v[200:203], v[48:51], v[72:75], v[200:203]
  s_add_u32 m0, s28, 1024
  s_add_u32 s65, s68, 16384
  buffer_load_dwordx4 v7, s[44:47], s65 offen lds
  v_mfma_f32_16x16x32_bf16 v[204:207], v[48:51], v[76:79], v[204:207]
  ds_read_b128 v[48:51], v3 offset:36864
  v_mfma_f32_16x16x32_bf16 v[208:211], v[64:67], v[52:55], v[208:211]
  v_mfma_f32_16x16x32_bf16 v[212:215], v[68:71], v[52:55], v[212:215]
  v_mfma_f32_16x16x32_bf16 v[216:219], v[52:55], v[72:75], v[216:219]
  v_mfma_f32_16x16x32_bf16 v[220:223], v[52:55], v[76:79], v[220:223]
  ds_read_b128 v[52:55], v3 offset:37888
  v_mfma_f32_16x16x32_bf16 v[224:227], v[64:67], v[56:59], v[224:227]
  s_add_u32 m0, s28, 16384
  s_nop 0
  buffer_load_dwordx4 v9, s[48:51], s69 offen lds
  v_mfma_f32_16x16x32_bf16 v[228:231], v[68:71], v[56:59], v[228:231]
  v_mfma_f32_16x16x32_bf16 v[232:235], v[56:59], v[72:75], v[232:235]
  v_mfma_f32_16x16x32_bf16 v[236:239], v[56:59], v[76:79], v[236:239]
  ds_read_b128 v[56:59], v3 offset:38912
  v_mfma_f32_16x16x32_bf16 v[240:243], v[64:67], v[60:63], v[240:243]
  v_mfma_f32_16x16x32_bf16 v[244:247], v[68:71], v[60:63], v[244:247]
  v_mfma_f32_16x16x32_bf16 v[248:251], v[60:63], v[72:75], v[248:251]
  s_add_u32 m0, s28, 17408
  s_nop 0
  buffer_load_dwordx4 v9, s[52:55], s69 offen lds
  s_add_u32 s68, s68, 64
  s_add_u32 s69, s69, 262144
  s_add_u32 s28, s28, 32768
  s_and_b32 s28, s28, 0x1ffff
  v_mfma_f32_16x16x32_bf16 v[252:255], v[60:63], v[76:79], v[252:255]
  ds_read_b128 v[60:63], v3 offset:39936
  s_waitcnt lgkmcnt(4)
  v_mfma_f32_16x16x32_bf16 v[128:131], v[80:83], v[32:35], v[128:131]
  v_mfma_f32_16x16x32_bf16 v[132:135], v[84:87], v[32:35], v[132:135]
  v_mfma_f32_16x16x32_bf16 v[136:139], v[32:35], v[88:91], v[136:139]
  v_mfma_f32_16x16x32_bf16 v[140:143], v[32:35], v[92:95], v[140:143]
  v_xor_b32 v3, 65536, v3
  v_xor_b32 v5, 65536, v5
  v_xor_b32 v6, 65536, v6
  v_mfma_f32_16x16x32_bf16 v[144:147], v[80:83], v[36:39], v[144:147]
  v_mfma_f32_16x16x32_bf16 v[148:151], v[84:87], v[36:39], v[148:151]
  v_mfma_f32_16x16x32_bf16 v[152:155], v[36:39], v[88:91], v[152:155]
  v_mfma_f32_16x16x32_bf16 v[156:159], v[36:39], v[92:95], v[156:159]
  s_waitcnt vmcnt(10) lgkmcnt(0)
  s_barrier
  v_mfma_f32_16x16x32_bf16 v[160:163], v[80:83], v[40:43], v[160:163]
  ds_read_b128 v[32:35], v3 offset:0
  v_mfma_f32_16x16x32_bf16 v[164:167], v[84:87], v[40:43], v[164:167]
  ds_read_b128 v[36:39], v3 offset:1024
  v_mfma_f32_16x16x32_bf16 v[168:171], v[40:43], v[88:91], v[168:171]
  ds_read_b64_tr_b16 v[64:65], v5 offset:0
  v_mfma_f32_16x16x32_bf16 v[172:175], v[40:43], v[92:95], v[172:175]
  ds_read_b64_tr_b16 v[66:67], v5 offset:2048
  ds_read_b128 v[40:43], v3 offset:2048
  v_mfma_f32_16x16x32_bf16 v[176:179], v[80:83], v[44:47], v[176:179]
  ds_read_b64_tr_b16 v[68:69], v6 offset:0
  s_add_u32 m0, s28, 0
  s_add_u32 s65, s68, 0
  buffer_load_dwordx4 v7, s[44:47], s65 offen lds
  v_mfma_f32_16x16x32_bf16 v[180:183], v[84:87], v[44:47], v[180:183]
  ds_read_b64_tr_b16 v[70:71], v6 offset:2048
  v_mfma_f32_16x16x32_bf16 v[184:187], v[44:47], v[88:91], v[184:187]
  ds_read_b64_tr_b16 v[72:73], v5 offset:1024
  v_mfma_f32_16x16x32_bf16 v[188:191], v[44:47], v[92:95], v[188:191]
  ds_read_b64_tr_b16 v[74:75], v5 offset:3072
  ds_read_b128 v[44:47], v3 offset:3072
  v_mfma_f32_16x16x32_bf16 v[192:195], v[80:83], v[48:51], v[192:195]
  ds_read_b64_tr_b16 v[76:77], v6 offset:1024
  v_mfma_f32_16x16x32_bf16 v[196:199], v[84:87], v[48:51], v[196:199]
  ds_read_b64_tr_b16 v[78:79], v6 offset:3072
  v_mfma_f32_16x16x32_bf16 v[200:203], v[48:51], v[88:91], v[200:203]
  s_add_u32 m0, s28, 1024
  s_add_u32 s65, s68, 16384
  buffer_load_dwordx4 v7, s[44:47], s65 offen lds
  v_mfma_f32_16x16x32_bf16 v[204:207], v[48:51], v[92:95], v[204:207]
  ds_read_b128 v[48:51], v3 offset:4096
  v_mfma_f32_16x16x32_bf16 v[208:211], v[80:83], v[52:55], v[208:211]
  v_mfma_f32_16x16x32_bf16 v[212:215], v[84:87], v[52:55], v[212:215]
  v_mfma_f32_16x16x32_bf16 v[216:219], v[52:55], v[88:91], v[216:219]
  v_mfma_f32_16x16x32_bf16 v[220:223], v[52:55], v[92:95], v[220:223]
  ds_read_b128 v[52:55], v3 offset:5120
  v_mfma_f32_16x16x32_bf16 v[224:227], v[80:83], v[56:59], v[224:227]
  s_add_u32 m0, s28, 16384
  s_nop 0
  buffer_load_dwordx4 v9, s[48:51], s69 offen lds
  v_mfma_f32_16x16x32_bf16 v[228:231], v[84:87], v[56:59], v[228:231]
  v_mfma_f32_16x16x32_bf16 v[232:235], v[56:59], v[88:91], v[232:235]
  v_mfma_f32_16x16x32_bf16 v[236:239], v[56:59], v[92:95], v[236:239]
  ds_read_b128 v[56:59], v3 offset:6144
  v_mfma_f32_16x16x32_bf16 v[240:243], v[80:83], v[60:63], v[240:243]
  v_mfma_f32_16x16x32_bf16 v[244:247], v[84:87], v[60:63], v[244:247]
  v_mfma_f32_16x16x32_bf16 v[248:251], v[60:63], v[88:91], v[248:251]
  s_add_u32 m0, s28, 17408
  s_nop 0
  buffer_load_dwordx4 v9, s[52:55], s69 offen lds
  s_add_u32 s68, s68, 64
  s_add_u32 s69, s69, 262144
  s_add_u32 s28, s28, 32768
  s_and_b32 s28, s28, 0x1ffff
  v_mfma_f32_16x16x32_bf16 v[252:255], v[60:63], v[92:95], v[252:255]
  ds_read_b128 v[60:63], v3 offset:7168
  s_waitcnt lgkmcnt(4)
  v_mfma_f32_16x16x32_bf16 v[128:131], v[64:67], v[32:35], v[128:131]
  v_mfma_f32_16x16x32_bf16 v[132:135], v[68:71], v[32:35], v[132:135]
  v_mfma_f32_16x16x32_bf16 v[136:139], v[32:35], v[72:75], v[136:139]
  v_mfma_f32_16x16x32_bf16 v[140:143], v[32:35], v[76:79], v[140:143]
  v_mfma_f32_16x16x32_bf16 v[144:147], v[64:67], v[36:39], v[144:147]
  v_mfma_f32_16x16x32_bf16 v[148:151], v[68:71], v[36:39], v[148:151]
  v_mfma_f32_16x16x32_bf16 v[152:155], v[36:39], v[72:75], v[152:155]
  v_mfma_f32_16x16x32_bf16 v[156:159], v[36:39], v[76:79], v[156:159]
  s_waitcnt vmcnt(10) lgkmcnt(0)
  s_barrier
  v_mfma_f32_16x16x32_bf16 v[160:163], v[64:67], v[40:43], v[160:163]
  ds_read_b128 v[32:35], v3 offset:32768
  v_mfma_f32_16x16x32_bf16 v[164:167], v[68:71], v[40:43], v[164:167]
  ds_read_b128 v[36:39], v3 offset:33792
  v_mfma_f32_16x16x32_bf16 v[168:171], v[40:43], v[72:75], v[168:171]
  s_bfe_u32 s65, s2, 0x20003
  s_cmp_lg_u32 s65, 0
  s_cbranch_scc1 L_sln_1
  s_cmp_lg_u32 s3, 4
  s_cbranch_scc1 L_sig_2
  s_mov_b64 exec, 1
  v_mov_b32 v0, 1
  buffer_store_byte v0, off, s[4:7], s2 sc1
  s_mov_b64 exec, -1
L_sig_2:
L_sln_1:
  ds_read_b64_tr_b16 v[80:81], v5 offset:32768
  v_mfma_f32_16x16x32_bf16 v[172:175], v[40:43], v[76:79], v[172:175]
  ds_read_b64_tr_b16 v[82:83], v5 offset:34816
  ds_read_b128 v[40:43], v3 offset:34816
  v_mfma_f32_16x16x32_bf16 v[176:179], v[64:67], v[44:47], v[176:179]
  ds_read_b64_tr_b16 v[84:85], v6 offset:32768
  s_add_u32 m0, s28, 0
  s_add_u32 s65, s68, 0
  buffer_load_dwordx4 v7, s[44:47], s65 offen lds
  v_mfma_f32_16x16x32_bf16 v[180:183], v[68:71], v[44:47], v[180:183]
  ds_read_b64_tr_b16 v[86:87], v6 offset:34816
  v_mfma_f32_16x16x32_bf16 v[184:187], v[44:47], v[72:75], v[184:187]
  ds_read_b64_tr_b16 v[88:89], v5 offset:33792
  v_mfma_f32_16x16x32_bf16 v[188:191], v[44:47], v[76:79], v[188:191]
  ds_read_b64_tr_b16 v[90:91], v5 offset:35840
  ds_read_b128 v[44:47], v3 offset:35840
  v_mfma_f32_16x16x32_bf16 v[192:195], v[64:67], v[48:51], v[192:195]
  ds_read_b64_tr_b16 v[92:93], v6 offset:33792
  v_mfma_f32_16x16x32_bf16 v[196:199], v[68:71], v[48:51], v[196:199]
  ds_read_b64_tr_b16 v[94:95], v6 offset:35840
  v_mfma_f32_16x16x32_bf16 v[200:203], v[48:51], v[72:75], v[200:203]
  s_add_u32 m0, s28, 1024
  s_add_u32 s65, s68, 16384
  buffer_load_dwordx4 v7, s[44:47], s65 offen lds
  v_mfma_f32_16x16x32_bf16 v[204:207], v[48:51], v[76:79], v[204:207]
  ds_read_b128 v[48:51], v3 offset:36864
  v_mfma_f32_16x16x32_bf16 v[208:211], v[64:67], v[52:55], v[208:211]
  v_mfma_f32_16x16x32_bf16 v[212:215], v[68:71], v[52:55], v[212:215]
  v_mfma_f32_16x16x32_bf16 v[216:219], v[52:55], v[72:75], v[216:219]
  v_mfma_f32_16x16x32_bf16 v[220:223], v[52:55], v[76:79], v[220:223]
  ds_read_b128 v[52:55], v3 offset:37888
  v_mfma_f32_16x16x32_bf16 v[224:227], v[64:67], v[56:59], v[224:227]
  s_add_u32 m0, s28, 16384
  s_nop 0
  buffer_load_dwordx4 v9, s[48:51], s69 offen lds
  v_mfma_f32_16x16x32_bf16 v[228:231], v[68:71], v[56:59], v[228:231]
  v_mfma_f32_16x16x32_bf16 v[232:235], v[56:59], v[72:75], v[232:235]
  v_mfma_f32_16x16x32_bf16 v[236:239], v[56:59], v[76:79], v[236:239]
  ds_read_b128 v[56:59], v3 offset:38912
  v_mfma_f32_16x16x32_bf16 v[240:243], v[64:67], v[60:63], v[240:243]
  v_mfma_f32_16x16x32_bf16 v[244:247], v[68:71], v[60:63], v[244:247]
  v_mfma_f32_16x16x32_bf16 v[248:251], v[60:63], v[72:75], v[248:251]
  s_add_u32 m0, s28, 17408
  s_nop 0
  buffer_load_dwordx4 v9, s[52:55], s69 offen lds
  s_add_u32 s68, s68, 64
  s_add_u32 s69, s69, 262144
  s_add_u32 s28, s28, 32768
  s_and_b32 s28, s28, 0x1ffff
  v_mfma_f32_16x16x32_bf16 v[252:255], v[60:63], v[76:79], v[252:255]
  ds_read_b128 v[60:63], v3 offset:39936
  s_waitcnt lgkmcnt(4)
  v_mfma_f32_16x16x32_bf16 v[128:131], v[80:83], v[32:35], v[128:131]
  v_mfma_f32_16x16x32_bf16 v[132:135], v[84:87], v[32:35], v[132:135]
  v_mfma_f32_16x16x32_bf16 v[136:139], v[32:35], v[88:91], v[136:139]
  v_mfma_f32_16x16x32_bf16 v[140:143], v[32:35], v[92:95], v[140:143]
  v_xor_b32 v3, 65536, v3
  v_xor_b32 v5, 65536, v5
  v_xor_b32 v6, 65536, v6
  v_mfma_f32_16x16x32_bf16 v[144:147], v[80:83], v[36:39], v[144:147]
  v_mfma_f32_16x16x32_bf16 v[148:151], v[84:87], v[36:39], v[148:151]
  v_mfma_f32_16x16x32_bf16 v[152:155], v[36:39], v[88:91], v[152:155]
  v_mfma_f32_16x16x32_bf16 v[156:159], v[36:39], v[92:95], v[156:159]
  s_waitcnt vmcnt(8) lgkmcnt(0)
  s_barrier
  v_mfma_f32_16x16x32_bf16 v[160:163], v[80:83], v[40:43], v[160:163]
  ds_read_b128 v[32:35], v3 offset:0
  v_mfma_f32_16x16x32_bf16 v[164:167], v[84:87], v[40:43], v[164:167]
  ds_read_b128 v[36:39], v3 offset:1024
  v_mfma_f32_16x16x32_bf16 v[168:171], v[40:43], v[88:91], v[168:171]
  s_bfe_u32 s65, s2, 0x20003
  s_cmp_lg_u32 s65, 1
  s_cbranch_scc1 L_sln_3
  s_cmp_lg_u32 s3, 4
  s_cbranch_scc1 L_sig_4
  s_mov_b64 exec, 1
  v_mov_b32 v0, 1
  buffer_store_byte v0, off, s[4:7], s2 sc1
  s_mov_b64 exec, -1
L_sig_4:
L_sln_3:
  ds_read_b64_tr_b16 v[64:65], v5 offset:0
  v_mfma_f32_16x16x32_bf16 v[172:175], v[40:43], v[92:95], v[172:175]
  ds_read_b64_tr_b16 v[66:67], v5 offset:2048
  ds_read_b128 v[40:43], v3 offset:2048
  v_mfma_f32_16x16x32_bf16 v[176:179], v[80:83], v[44:47], v[176:179]
  ds_read_b64_tr_b16 v[68:69], v6 offset:0
  s_add_u32 m0, s28, 0
  s_add_u32 s65, s68, 0
  buffer_load_dwordx4 v7, s[44:47], s65 offen lds
  v_mfma_f32_16x16x32_bf16 v[180:183], v[84:87], v[44:47], v[180:183]
  ds_read_b64_tr_b16 v[70:71], v6 offset:2048
  v_mfma_f32_16x16x32_bf16 v[184:187], v[44:47], v[88:91], v[184:187]
  ds_read_b64_tr_b16 v[72:73], v5 offset:1024
  v_mfma_f32_16x16x32_bf16 v[188:191], v[44:47], v[92:95], v[188:191]
  ds_read_b64_tr_b16 v[74:75], v5 offset:3072
  ds_read_b128 v[44:47], v3 offset:3072
  v_mfma_f32_16x16x32_bf16 v[192:195], v[80:83], v[48:51], v[192:195]
  ds_read_b64_tr_b16 v[76:77], v6 offset:1024
  v_mfma_f32_16x16x32_bf16 v[196:199], v[84:87], v[48:51], v[196:199]
  ds_read_b64_tr_b16 v[78:79], v6 offset:3072
  v_mfma_f32_16x16x32_bf16 v[200:203], v[48:51], v[88:91], v[200:203]
  s_add_u32 m0, s28, 1024
  s_add_u32 s65, s68, 16384
  buffer_load_dwordx4 v7, s[44:47], s65 offen lds
  v_mfma_f32_16x16x32_bf16 v[204:207], v[48:51], v[92:95], v[204:207]
  ds_read_b128 v[48:51], v3 offset:4096
  v_mfma_f32_16x16x32_bf16 v[208:211], v[80:83], v[52:55], v[208:211]
  v_mfma_f32_16x16x32_bf16 v[212:215], v[84:87], v[52:55], v[212:215]
  v_mfma_f32_16x16x32_bf16 v[216:219], v[52:55], v[88:91], v[216:219]
  v_mfma_f32_16x16x32_bf16 v[220:223], v[52:55], v[92:95], v[220:223]
  ds_read_b128 v[52:55], v3 offset:5120
  v_mfma_f32_16x16x32_bf16 v[224:227], v[80:83], v[56:59], v[224:227]
  s_add_u32 m0, s28, 16384
  s_nop 0
  buffer_load_dwordx4 v9, s[48:51], s69 offen lds
  v_mfma_f32_16x16x32_bf16 v[228:231], v[84:87], v[56:59], v[228:231]
  v_mfma_f32_16x16x32_bf16 v[232:235], v[56:59], v[88:91], v[232:235]
  v_mfma_f32_16x16x32_bf16 v[236:239], v[56:59], v[92:95], v[236:239]
  ds_read_b128 v[56:59], v3 offset:6144
  v_mfma_f32_16x16x32_bf16 v[240:243], v[80:83], v[60:63], v[240:243]
  v_mfma_f32_16x16x32_bf16 v[244:247], v[84:87], v[60:63], v[244:247]
  v_mfma_f32_16x16x32_bf16 v[248:251], v[60:63], v[88:91], v[248:251]
  s_add_u32 m0, s28, 17408
  s_nop 0
  buffer_load_dwordx4 v9, s[52:55], s69 offen lds
  s_add_u32 s68, s68, 64
  s_add_u32 s69, s69, 262144
  s_add_u32 s28, s28, 32768
  s_and_b32 s28, s28, 0x1ffff
  v_mfma_f32_16x16x32_bf16 v[252:255], v[60:63], v[92:95], v[252:255]
  ds_read_b128 v[60:63], v3 offset:7168
  s_waitcnt lgkmcnt(4)
  v_mfma_f32_16x16x32_bf16 v[128:131], v[64:67], v[32:35], v[128:131]
  v_mfma_f32_16x16x32_bf16 v[132:135], v[68:71], v[32:35], v[132:135]
  v_mfma_f32_16x16x32_bf16 v[136:139], v[32:35], v[72:75], v[136:139]
  v_mfma_f32_16x16x32_bf16 v[140:143], v[32:35], v[76:79], v[140:143]
  v_mfma_f32_16x16x32_bf16 v[144:147], v[64:67], v[36:39], v[144:147]
  v_mfma_f32_16x16x32_bf16 v[148:151], v[68:71], v[36:39], v[148:151]
  v_mfma_f32_16x16x32_bf16 v[152:155], v[36:39], v[72:75], v[152:155]
  v_mfma_f32_16x16x32_bf16 v[156:159], v[36:39], v[76:79], v[156:159]
  s_waitcnt vmcnt(8) lgkmcnt(0)
  s_barrier
  v_mfma_f32_16x16x32_bf16 v[160:163], v[64:67], v[40:43], v[160:163]
  ds_read_b128 v[32:35], v3 offset:32768
  v_mfma_f32_16x16x32_bf16 v[164:167], v[68:71], v[40:43], v[164:167]
  ds_read_b128 v[36:39], v3 offset:33792
  v_mfma_f32_16x16x32_bf16 v[168:171], v[40:43], v[72:75], v[168:171]
  s_bfe_u32 s65, s2, 0x20003
  s_cmp_lg_u32 s65, 2
  s_cbranch_scc1 L_sln_5
  s_cmp_lg_u32 s3, 4
  s_cbranch_scc1 L_sig_6
  s_mov_b64 exec, 1
  v_mov_b32 v0, 1
  buffer_store_byte v0, off, s[4:7], s2 sc1
  s_mov_b64 exec, -1
L_sig_6:
L_sln_5:
  ds_read_b64_tr_b16 v[80:81], v5 offset:32768
  v_mfma_f32_16x16x32_bf16 v[172:175], v[40:43], v[76:79], v[172:175]
  ds_read_b64_tr_b16 v[82:83], v5 offset:34816
  ds_read_b128 v[40:43], v3 offset:34816
  v_mfma_f32_16x16x32_bf16 v[176:179], v[64:67], v[44:47], v[176:179]
  ds_read_b64_tr_b16 v[84:85], v6 offset:32768
  s_add_u32 m0, s28, 0
  s_add_u32 s65, s68, 0
  buffer_load_dwordx4 v7, s[44:47], s65 offen lds
  v_mfma_f32_16x16x32_bf16 v[180:183], v[68:71], v[44:47], v[180:183]
  ds_read_b64_tr_b16 v[86:87], v6 offset:34816
  v_mfma_f32_16x16x32_bf16 v[184:187], v[44:47], v[72:75], v[184:187]
  ds_read_b64_tr_b16 v[88:89], v5 offset:33792
  v_mfma_f32_16x16x32_bf16 v[188:191], v[44:47], v[76:79], v[188:191]
  ds_read_b64_tr_b16 v[90:91], v5 offset:35840
  ds_read_b128 v[44:47], v3 offset:35840
  v_mfma_f32_16x16x32_bf16 v[192:195], v[64:67], v[48:51], v[192:195]
  ds_read_b64_tr_b16 v[92:93], v6 offset:33792
  v_mfma_f32_16x16x32_bf16 v[196:199], v[68:71], v[48:51], v[196:199]
  ds_read_b64_tr_b16 v[94:95], v6 offset:35840
  v_mfma_f32_16x16x32_bf16 v[200:203], v[48:51], v[72:75], v[200:203]
  s_add_u32 m0, s28, 1024
  s_add_u32 s65, s68, 16384
  buffer_load_dwordx4 v7, s[44:47], s65 offen lds
  v_mfma_f32_16x16x32_bf16 v[204:207], v[48:51], v[76:79], v[204:207]
  ds_read_b128 v[48:51], v3 offset:36864
  v_mfma_f32_16x16x32_bf16 v[208:211], v[64:67], v[52:55], v[208:211]
  v_mfma_f32_16x16x32_bf16 v[212:215], v[68:71], v[52:55], v[212:215]
  v_mfma_f32_16x16x32_bf16 v[216:219], v[52:55], v[72:75], v[216:219]
  v_mfma_f32_16x16x32_bf16 v[220:223], v[52:55], v[76:79], v[220:223]
  ds_read_b128 v[52:55], v3 offset:37888
  v_mfma_f32_16x16x32_bf16 v[224:227], v[64:67], v[56:59], v[224:227]
  s_add_u32 m0, s28, 16384
  s_nop 0
  buffer_load_dwordx4 v9, s[48:51], s69 offen lds
  v_mfma_f32_16x16x32_bf16 v[228:231], v[68:71], v[56:59], v[228:231]
  v_mfma_f32_16x16x32_bf16 v[232:235], v[56:59], v[72:75], v[232:235]
  v_mfma_f32_16x16x32_bf16 v[236:239], v[56:59], v[76:79], v[236:239]
  ds_read_b128 v[56:59], v3 offset:38912
  v_mfma_f32_16x16x32_bf16 v[240:243], v[64:67], v[60:63], v[240:243]
  v_mfma_f32_16x16x32_bf16 v[244:247], v[68:71], v[60:63], v[244:247]
  v_mfma_f32_16x16x32_bf16 v[248:251], v[60:63], v[72:75], v[248:251]
  s_add_u32 m0, s28, 17408
  s_nop 0
  buffer_load_dwordx4 v9, s[52:55], s69 offen lds
  s_add_u32 s68, s68, 64
  s_add_u32 s69, s69, 262144
  s_add_u32 s28, s28, 32768
  s_and_b32 s28, s28, 0x1ffff
  v_mfma_f32_16x16x32_bf16 v[252:255], v[60:63], v[76:79], v[252:255]
  ds_read_b128 v[60:63], v3 offset:39936
  s_waitcnt lgkmcnt(4)
  v_mfma_f32_16x16x32_bf16 v[128:131], v[80:83], v[32:35], v[128:131]
  v_mfma_f32_16x16x32_bf16 v[132:135], v[84:87], v[32:35], v[132:135]
  v_mfma_f32_16x16x32_bf16 v[136:139], v[32:35], v[88:91], v[136:139]
  v_mfma_f32_16x16x32_bf16 v[140:143], v[32:35], v[92:95], v[140:143]
  v_xor_b32 v3, 65536, v3
  v_xor_b32 v5, 65536, v5
  v_xor_b32 v6, 65536, v6
  v_mfma_f32_16x16x32_bf16 v[144:147], v[80:83], v[36:39], v[144:147]
  v_mfma_f32_16x16x32_bf16 v[148:151], v[84:87], v[36:39], v[148:151]
  v_mfma_f32_16x16x32_bf16 v[152:155], v[36:39], v[88:91], v[152:155]
  v_mfma_f32_16x16x32_bf16 v[156:159], v[36:39], v[92:95], v[156:159]
  s_waitcnt vmcnt(8) lgkmcnt(0)
  s_barrier
  v_mfma_f32_16x16x32_bf16 v[160:163], v[80:83], v[40:43], v[160:163]
  ds_read_b128 v[32:35], v3 offset:0
  v_mfma_f32_16x16x32_bf16 v[164:167], v[84:87], v[40:43], v[164:167]
  ds_read_b128 v[36:39], v3 offset:1024
  v_mfma_f32_16x16x32_bf16 v[168:171], v[40:43], v[88:91], v[168:171]
  s_bfe_u32 s65, s2, 0x20003
  s_cmp_lg_u32 s65, 3
  s_cbranch_scc1 L_sln_7
  s_cmp_lg_u32 s3, 4
  s_cbranch_scc1 L_sig_8
  s_mov_b64 exec, 1
  v_mov_b32 v0, 1
  buffer_store_byte v0, off, s[4:7], s2 sc1
  s_mov_b64 exec, -1
L_sig_8:
L_sln_7:
  ds_read_b64_tr_b16 v[64:65], v5 offset:0
  v_mfma_f32_16x16x32_bf16 v[172:175], v[40:43], v[92:95], v[172:175]
  ds_read_b64_tr_b16 v[66:67], v5 offset:2048
  ds_read_b128 v[40:43], v3 offset:2048
  v_mfma_f32_16x16x32_bf16 v[176:179], v[80:83], v[44:47], v[176:179]
  ds_read_b64_tr_b16 v[68:69], v6 offset:0
  s_add_u32 m0, s28, 0
  s_add_u32 s65, s68, 0
  buffer_load_dwordx4 v7, s[44:47], s65 offen lds
  v_mfma_f32_16x16x32_bf16 v[180:183], v[84:87], v[44:47], v[180:183]
  ds_read_b64_tr_b16 v[70:71], v6 offset:2048
  v_mfma_f32_16x16x32_bf16 v[184:187], v[44:47], v[88:91], v[184:187]
  ds_read_b64_tr_b16 v[72:73], v5 offset:1024
  v_mfma_f32_16x16x32_bf16 v[188:191], v[44:47], v[92:95], v[188:191]
  ds_read_b64_tr_b16 v[74:75], v5 offset:3072
  ds_read_b128 v[44:47], v3 offset:3072
  v_mfma_f32_16x16x32_bf16 v[192:195], v[80:83], v[48:51], v[192:195]
  ds_read_b64_tr_b16 v[76:77], v6 offset:1024
  v_mfma_f32_16x16x32_bf16 v[196:199], v[84:87], v[48:51], v[196:199]
  ds_read_b64_tr_b16 v[78:79], v6 offset:3072
  v_mfma_f32_16x16x32_bf16 v[200:203], v[48:51], v[88:91], v[200:203]
  s_add_u32 m0, s28, 1024
  s_add_u32 s65, s68, 16384
  buffer_load_dwordx4 v7, s[44:47], s65 offen lds
  v_mfma_f32_16x16x32_bf16 v[204:207], v[48:51], v[92:95], v[204:207]
  ds_read_b128 v[48:51], v3 offset:4096
  v_mfma_f32_16x16x32_bf16 v[208:211], v[80:83], v[52:55], v[208:211]
  v_mfma_f32_16x16x32_bf16 v[212:215], v[84:87], v[52:55], v[212:215]
  v_mfma_f32_16x16x32_bf16 v[216:219], v[52:55], v[88:91], v[216:219]
  v_mfma_f32_16x16x32_bf16 v[220:223], v[52:55], v[92:95], v[220:223]
  ds_read_b128 v[52:55], v3 offset:5120
  v_mfma_f32_16x16x32_bf16 v[224:227], v[80:83], v[56:59], v[224:227]
  s_add_u32 m0, s28, 16384
  s_nop 0
  buffer_load_dwordx4 v9, s[48:51], s69 offen lds
  v_mfma_f32_16x16x32_bf16 v[228:231], v[84:87], v[56:59], v[228:231]
  v_mfma_f32_16x16x32_bf16 v[232:235], v[56:59], v[88:91], v[232:235]
  v_mfma_f32_16x16x32_bf16 v[236:239], v[56:59], v[92:95], v[236:239]
  ds_read_b128 v[56:59], v3 offset:6144
  v_mfma_f32_16x16x32_bf16 v[240:243], v[80:83], v[60:63], v[240:243]
  v_mfma_f32_16x16x32_bf16 v[244:247], v[84:87], v[60:63], v[244:247]
  v_mfma_f32_16x16x32_bf16 v[248:251], v[60:63], v[88:91], v[248:251]
  s_add_u32 m0, s28, 17408
  s_nop 0
  buffer_load_dwordx4 v9, s[52:55], s69 offen lds
  s_add_u32 s68, s68, 64
  s_add_u32 s69, s69, 262144
  s_add_u32 s28, s28, 32768
  s_and_b32 s28, s28, 0x1ffff
  v_mfma_f32_16x16x32_bf16 v[252:255], v[60:63], v[92:95], v[252:255]
  ds_read_b128 v[60:63], v3 offset:7168
  s_waitcnt lgkmcnt(4)
  v_mfma_f32_16x16x32_bf16 v[128:131], v[64:67], v[32:35], v[128:131]
  v_mfma_f32_16x16x32_bf16 v[132:135], v[68:71], v[32:35], v[132:135]
  v_mfma_f32_16x16x32_bf16 v[136:139], v[32:35], v[72:75], v[136:139]
  v_mfma_f32_16x16x32_bf16 v[140:143], v[32:35], v[76:79], v[140:143]
  v_mfma_f32_16x16x32_bf16 v[144:147], v[64:67], v[36:39], v[144:147]
  v_mfma_f32_16x16x32_bf16 v[148:151], v[68:71], v[36:39], v[148:151]
  v_mfma_f32_16x16x32_bf16 v[152:155], v[36:39], v[72:75], v[152:155]
  v_mfma_f32_16x16x32_bf16 v[156:159], v[36:39], v[76:79], v[156:159]
  s_waitcnt vmcnt(8) lgkmcnt(0)
  s_barrier
  v_mfma_f32_16x16x32_bf16 v[160:163], v[64:67], v[40:43], v[160:163]
  ds_read_b128 v[32:35], v3 offset:32768
  v_mfma_f32_16x16x32_bf16 v[164:167], v[68:71], v[40:43], v[164:167]
  ds_read_b128 v[36:39], v3 offset:33792
  v_mfma_f32_16x16x32_bf16 v[168:171], v[40:43], v[72:75], v[168:171]
  s_mov_b64 vcc, -1
  s_cmp_eq_u32 s63, 0
  s_cselect_b32 s52, s30, s32
  s_cselect_b32 s53, s31, s33
  s_mov_b32 s54, 1409024
  s_mov_b32 m0, s16
  s_nop 0
  buffer_load_dwordx4 v9, s[12:15], s29 offen lds
  s_add_u32 m0, s16, 8192
  s_add_u32 s29, s29, 262144
  buffer_load_dwordx4 v10, s[52:55], s43 offen lds
  s_add_u32 s43, s43, 88064
  s_add_u32 s16, s16, 16384
  s_and_b32 s16, s16, 0x1ffff
  s_mov_b32 m0, s16
  s_nop 0
  buffer_load_dwordx4 v9, s[12:15], s29 offen lds
  s_add_u32 m0, s16, 8192
  s_add_u32 s29, s29, 262144
  buffer_load_dwordx4 v10, s[52:55], s43 offen lds
  s_add_u32 s43, s43, 88064
  s_add_u32 s16, s16, 16384
  s_and_b32 s16, s16, 0x1ffff
  ds_read_b64_tr_b16 v[80:81], v5 offset:32768
  v_mfma_f32_16x16x32_bf16 v[172:175], v[40:43], v[76:79], v[172:175]
  ds_read_b64_tr_b16 v[82:83], v5 offset:34816
  ds_read_b128 v[40:43], v3 offset:34816
  v_mfma_f32_16x16x32_bf16 v[176:179], v[64:67], v[44:47], v[176:179]
  ds_read_b64_tr_b16 v[84:85], v6 offset:32768
  v_mfma_f32_16x16x32_bf16 v[180:183], v[68:71], v[44:47], v[180:183]
  ds_read_b64_tr_b16 v[86:87], v6 offset:34816
  v_mfma_f32_16x16x32_bf16 v[184:187], v[44:47], v[72:75], v[184:187]
  ds_read_b64_tr_b16 v[88:89], v5 offset:33792
  v_mfma_f32_16x16x32_bf16 v[188:191], v[44:47], v[76:79], v[188:191]
  ds_read_b64_tr_b16 v[90:91], v5 offset:35840
  ds_read_b128 v[44:47], v3 offset:35840
  v_mfma_f32_16x16x32_bf16 v[192:195], v[64:67], v[48:51], v[192:195]
  ds_read_b64_tr_b16 v[92:93], v6 offset:33792
  v_mfma_f32_16x16x32_bf16 v[196:199], v[68:71], v[48:51], v[196:199]
  ds_read_b64_tr_b16 v[94:95], v6 offset:35840
  v_mfma_f32_16x16x32_bf16 v[200:203], v[48:51], v[72:75], v[200:203]
  v_mfma_f32_16x16x32_bf16 v[204:207], v[48:51], v[76:79], v[204:207]
  ds_read_b128 v[48:51], v3 offset:36864
  v_mfma_f32_16x16x32_bf16 v[208:211], v[64:67], v[52:55], v[208:211]
  v_mfma_f32_16x16x32_bf16 v[212:215], v[68:71], v[52:55], v[212:215]
  v_mfma_f32_16x16x32_bf16 v[216:219], v[52:55], v[72:75], v[216:219]
  v_mfma_f32_16x16x32_bf16 v[220:223], v[52:55], v[76:79], v[220:223]
  ds_read_b128 v[52:55], v3 offset:37888
  v_mfma_f32_16x16x32_bf16 v[224:227], v[64:67], v[56:59], v[224:227]
  v_mfma_f32_16x16x32_bf16 v[228:231], v[68:71], v[56:59], v[228:231]
  v_mfma_f32_16x16x32_bf16 v[232:235], v[56:59], v[72:75], v[232:235]
  v_mfma_f32_16x16x32_bf16 v[236:239], v[56:59], v[76:79], v[236:239]
  ds_read_b128 v[56:59], v3 offset:38912
  v_mfma_f32_16x16x32_bf16 v[240:243], v[64:67], v[60:63], v[240:243]
  v_mfma_f32_16x16x32_bf16 v[244:247], v[68:71], v[60:63], v[244:247]
  v_mfma_f32_16x16x32_bf16 v[248:251], v[60:63], v[72:75], v[248:251]
  v_mfma_f32_16x16x32_bf16 v[252:255], v[60:63], v[76:79], v[252:255]
  ds_read_b128 v[60:63], v3 offset:39936
  s_waitcnt lgkmcnt(4)
  v_mfma_f32_16x16x32_bf16 v[128:131], v[80:83], v[32:35], v[128:131]
  v_mfma_f32_16x16x32_bf16 v[132:135], v[84:87], v[32:35], v[132:135]
  v_mfma_f32_16x16x32_bf16 v[136:139], v[32:35], v[88:91], v[136:139]
  v_mfma_f32_16x16x32_bf16 v[140:143], v[32:35], v[92:95], v[140:143]
  v_xor_b32 v3, 65536, v3
  v_xor_b32 v5, 65536, v5
  v_xor_b32 v6, 65536, v6
  v_mfma_f32_16x16x32_bf16 v[144:147], v[80:83], v[36:39], v[144:147]
  v_mfma_f32_16x16x32_bf16 v[148:151], v[84:87], v[36:39], v[148:151]
  v_mfma_f32_16x16x32_bf16 v[152:155], v[36:39], v[88:91], v[152:155]
  v_mfma_f32_16x16x32_bf16 v[156:159], v[36:39], v[92:95], v[156:159]
  s_waitcnt vmcnt(8) lgkmcnt(0)
  s_barrier
  v_mfma_f32_16x16x32_bf16 v[160:163], v[80:83], v[40:43], v[160:163]
  ds_read_b128 v[32:35], v3 offset:0
  v_mfma_f32_16x16x32_bf16 v[164:167], v[84:87], v[40:43], v[164:167]
  ds_read_b128 v[36:39], v3 offset:1024
  v_mfma_f32_16x16x32_bf16 v[168:171], v[40:43], v[88:91], v[168:171]
  s_cmp_lg_u32 s3, 4
  s_cbranch_scc1 L_wlnd_10
  v_lshrrev_b32 v16, 2, v2
L_wln_9:
  buffer_load_dword v0, v16, s[4:7], 0 offen sc1
  s_waitcnt vmcnt(0)
  v_lshrrev_b32 v17, 1, v0
  v_or_b32 v0, v0, v17
  v_and_b32 v0, 0x01010101, v0
  v_xor_b32 v0, 0x01010101, v0
  v_cmp_ne_u32 s[18:19], 0, v0
  s_cmp_eq_u64 s[18:19], 0
  s_cbranch_scc1 L_wlnd_10
  s_sleep 16
  s_branch L_wln_9
L_wlnd_10:
  s_mov_b32 m0, s16
  s_nop 0
  buffer_load_dwordx4 v9, s[12:15], s29 offen lds
  s_add_u32 m0, s16, 8192
  s_add_u32 s29, s29, 262144
  buffer_load_dwordx4 v10, s[52:55], s43 offen lds
  s_add_u32 s43, s43, 88064
  s_add_u32 s16, s16, 16384
  s_and_b32 s16, s16, 0x1ffff
  s_mov_b32 m0, s16
  s_nop 0
  buffer_load_dwordx4 v9, s[12:15], s29 offen lds
  s_add_u32 m0, s16, 8192
  s_add_u32 s29, s29, 262144
  buffer_load_dwordx4 v10, s[52:55], s43 offen lds
  s_add_u32 s43, s43, 88064
  s_add_u32 s16, s16, 16384
  s_and_b32 s16, s16, 0x1ffff
  ds_read_b64_tr_b16 v[64:65], v5 offset:0
  v_mfma_f32_16x16x32_bf16 v[172:175], v[40:43], v[92:95], v[172:175]
  ds_read_b64_tr_b16 v[66:67], v5 offset:2048
  ds_read_b128 v[40:43], v3 offset:2048
  v_mfma_f32_16x16x32_bf16 v[176:179], v[80:83], v[44:47], v[176:179]
  ds_read_b64_tr_b16 v[68:69], v6 offset:0
  v_mfma_f32_16x16x32_bf16 v[180:183], v[84:87], v[44:47], v[180:183]
  ds_read_b64_tr_b16 v[70:71], v6 offset:2048
  v_mfma_f32_16x16x32_bf16 v[184:187], v[44:47], v[88:91], v[184:187]
  ds_read_b64_tr_b16 v[72:73], v5 offset:1024
  v_mfma_f32_16x16x32_bf16 v[188:191], v[44:47], v[92:95], v[188:191]
  ds_read_b64_tr_b16 v[74:75], v5 offset:3072
  ds_read_b128 v[44:47], v3 offset:3072
  v_mfma_f32_16x16x32_bf16 v[192:195], v[80:83], v[48:51], v[192:195]
  ds_read_b64_tr_b16 v[76:77], v6 offset:1024
  v_mfma_f32_16x16x32_bf16 v[196:199], v[84:87], v[48:51], v[196:199]
  ds_read_b64_tr_b16 v[78:79], v6 offset:3072
  v_mfma_f32_16x16x32_bf16 v[200:203], v[48:51], v[88:91], v[200:203]
  v_mfma_f32_16x16x32_bf16 v[204:207], v[48:51], v[92:95], v[204:207]
  ds_read_b128 v[48:51], v3 offset:4096
  v_mfma_f32_16x16x32_bf16 v[208:211], v[80:83], v[52:55], v[208:211]
  v_mfma_f32_16x16x32_bf16 v[212:215], v[84:87], v[52:55], v[212:215]
  v_mfma_f32_16x16x32_bf16 v[216:219], v[52:55], v[88:91], v[216:219]
  v_mfma_f32_16x16x32_bf16 v[220:223], v[52:55], v[92:95], v[220:223]
  ds_read_b128 v[52:55], v3 offset:5120
  v_mfma_f32_16x16x32_bf16 v[224:227], v[80:83], v[56:59], v[224:227]
  v_mfma_f32_16x16x32_bf16 v[228:231], v[84:87], v[56:59], v[228:231]
  v_mfma_f32_16x16x32_bf16 v[232:235], v[56:59], v[88:91], v[232:235]
  v_mfma_f32_16x16x32_bf16 v[236:239], v[56:59], v[92:95], v[236:239]
  ds_read_b128 v[56:59], v3 offset:6144
  v_mfma_f32_16x16x32_bf16 v[240:243], v[80:83], v[60:63], v[240:243]
  v_mfma_f32_16x16x32_bf16 v[244:247], v[84:87], v[60:63], v[244:247]
  v_mfma_f32_16x16x32_bf16 v[248:251], v[60:63], v[88:91], v[248:251]
  v_mfma_f32_16x16x32_bf16 v[252:255], v[60:63], v[92:95], v[252:255]
  ds_read_b128 v[60:63], v3 offset:7168
  s_waitcnt lgkmcnt(4)
  v_mfma_f32_16x16x32_bf16 v[128:131], v[64:67], v[32:35], v[128:131]
  v_mfma_f32_16x16x32_bf16 v[132:135], v[68:71], v[32:35], v[132:135]
  v_mfma_f32_16x16x32_bf16 v[136:139], v[32:35], v[72:75], v[136:139]
  v_mfma_f32_16x16x32_bf16 v[140:143], v[32:35], v[76:79], v[140:143]
  v_mfma_f32_16x16x32_bf16 v[144:147], v[64:67], v[36:39], v[144:147]
  v_mfma_f32_16x16x32_bf16 v[148:151], v[68:71], v[36:39], v[148:151]
  v_mfma_f32_16x16x32_bf16 v[152:155], v[36:39], v[72:75], v[152:155]
  v_mfma_f32_16x16x32_bf16 v[156:159], v[36:39], v[76:79], v[156:159]
  s_waitcnt vmcnt(8) lgkmcnt(0)
  s_barrier
  v_mfma_f32_16x16x32_bf16 v[160:163], v[64:67], v[40:43], v[160:163]
  ds_read_b128 v[32:35], v3 offset:32768
  v_mfma_f32_16x16x32_bf16 v[164:167], v[68:71], v[40:43], v[164:167]
  ds_read_b128 v[36:39], v3 offset:33792
  v_mfma_f32_16x16x32_bf16 v[168:171], v[40:43], v[72:75], v[168:171]
  s_mov_b32 m0, s16
  s_nop 0
  buffer_load_dwordx4 v9, s[12:15], s29 offen lds
  s_add_u32 m0, s16, 8192
  s_add_u32 s29, s29, 262144
  buffer_load_dwordx4 v10, s[52:55], s43 offen lds
  s_add_u32 s43, s43, 88064
  s_add_u32 s16, s16, 16384
  s_and_b32 s16, s16, 0x1ffff
  s_mov_b32 m0, s16
  s_nop 0
  buffer_load_dwordx4 v9, s[12:15], s29 offen lds
  s_add_u32 m0, s16, 8192
  s_add_u32 s29, s29, 262144
  buffer_load_dwordx4 v10, s[52:55], s43 offen lds
  s_add_u32 s43, s43, 88064
  s_add_u32 s16, s16, 16384
  s_and_b32 s16, s16, 0x1ffff
  s_add_u32 s65, s84, 0
  buffer_load_dwordx4 v[96:99], v2, s[56:59], s65 offen sc1
  s_add_u32 s65, s84, 16384
  buffer_load_dwordx4 v[100:103], v2, s[56:59], s65 offen sc1
  s_add_u32 s65, s84, 1024
  buffer_load_dwordx4 v[104:107], v2, s[56:59], s65 offen sc1
  s_add_u32 s65, s84, 17408
  buffer_load_dwordx4 v[108:111], v2, s[56:59], s65 offen sc1
  ds_read_b64_tr_b16 v[80:81], v5 offset:32768
  v_mfma_f32_16x16x32_bf16 v[172:175], v[40:43], v[76:79], v[172:175]
  ds_read_b64_tr_b16 v[82:83], v5 offset:34816
  ds_read_b128 v[40:43], v3 offset:34816
  v_mfma_f32_16x16x32_bf16 v[176:179], v[64:67], v[44:47], v[176:179]
  ds_read_b64_tr_b16 v[84:85], v6 offset:32768
  v_mfma_f32_16x16x32_bf16 v[180:183], v[68:71], v[44:47], v[180:183]
  ds_read_b64_tr_b16 v[86:87], v6 offset:34816
  v_mfma_f32_16x16x32_bf16 v[184:187], v[44:47], v[72:75], v[184:187]
  ds_read_b64_tr_b16 v[88:89], v5 offset:33792
  v_mfma_f32_16x16x32_bf16 v[188:191], v[44:47], v[76:79], v[188:191]
  ds_read_b64_tr_b16 v[90:91], v5 offset:35840
  ds_read_b128 v[44:47], v3 offset:35840
  v_mfma_f32_16x16x32_bf16 v[192:195], v[64:67], v[48:51], v[192:195]
  ds_read_b64_tr_b16 v[92:93], v6 offset:33792
  v_mfma_f32_16x16x32_bf16 v[196:199], v[68:71], v[48:51], v[196:199]
  ds_read_b64_tr_b16 v[94:95], v6 offset:35840
  v_mfma_f32_16x16x32_bf16 v[200:203], v[48:51], v[72:75], v[200:203]
  v_mfma_f32_16x16x32_bf16 v[204:207], v[48:51], v[76:79], v[204:207]
  ds_read_b128 v[48:51], v3 offset:36864
  v_mfma_f32_16x16x32_bf16 v[208:211], v[64:67], v[52:55], v[208:211]
  v_mfma_f32_16x16x32_bf16 v[212:215], v[68:71], v[52:55], v[212:215]
  v_mfma_f32_16x16x32_bf16 v[216:219], v[52:55], v[72:75], v[216:219]
  v_mfma_f32_16x16x32_bf16 v[220:223], v[52:55], v[76:79], v[220:223]
  ds_read_b128 v[52:55], v3 offset:37888
  v_mfma_f32_16x16x32_bf16 v[224:227], v[64:67], v[56:59], v[224:227]
  v_mfma_f32_16x16x32_bf16 v[228:231], v[68:71], v[56:59], v[228:231]
  v_mfma_f32_16x16x32_bf16 v[232:235], v[56:59], v[72:75], v[232:235]
  v_mfma_f32_16x16x32_bf16 v[236:239], v[56:59], v[76:79], v[236:239]
  ds_read_b128 v[56:59], v3 offset:38912
  v_mfma_f32_16x16x32_bf16 v[240:243], v[64:67], v[60:63], v[240:243]
  v_mfma_f32_16x16x32_bf16 v[244:247], v[68:71], v[60:63], v[244:247]
  v_mfma_f32_16x16x32_bf16 v[248:251], v[60:63], v[72:75], v[248:251]
  v_mfma_f32_16x16x32_bf16 v[252:255], v[60:63], v[76:79], v[252:255]
  ds_read_b128 v[60:63], v3 offset:39936
  s_waitcnt lgkmcnt(4)
  v_mfma_f32_16x16x32_bf16 v[128:131], v[80:83], v[32:35], v[128:131]
  v_mfma_f32_16x16x32_bf16 v[132:135], v[84:87], v[32:35], v[132:135]
  v_mfma_f32_16x16x32_bf16 v[136:139], v[32:35], v[88:91], v[136:139]
  v_mfma_f32_16x16x32_bf16 v[140:143], v[32:35], v[92:95], v[140:143]
  v_xor_b32 v3, 65536, v3
  v_xor_b32 v5, 65536, v5
  v_xor_b32 v6, 65536, v6
  v_mfma_f32_16x16x32_bf16 v[144:147], v[80:83], v[36:39], v[144:147]
  v_mfma_f32_16x16x32_bf16 v[148:151], v[84:87], v[36:39], v[148:151]
  v_mfma_f32_16x16x32_bf16 v[152:155], v[36:39], v[88:91], v[152:155]
  v_mfma_f32_16x16x32_bf16 v[156:159], v[36:39], v[92:95], v[156:159]
  s_waitcnt lgkmcnt(0)
  s_barrier
  v_mfma_f32_16x16x32_bf16 v[160:163], v[80:83], v[40:43], v[160:163]
  v_mfma_f32_16x16x32_bf16 v[164:167], v[84:87], v[40:43], v[164:167]
  v_mfma_f32_16x16x32_bf16 v[168:171], v[40:43], v[88:91], v[168:171]
  s_mov_b32 m0, s16
  s_nop 0
  buffer_load_dwordx4 v9, s[12:15], s29 offen lds
  s_add_u32 m0, s16, 8192
  s_add_u32 s29, s29, 262144
  buffer_load_dwordx4 v10, s[52:55], s43 offen lds
  s_add_u32 s43, s43, 88064
  s_add_u32 s16, s16, 16384
  s_and_b32 s16, s16, 0x1ffff
  s_mov_b32 m0, s16
  s_nop 0
  buffer_load_dwordx4 v9, s[12:15], s29 offen lds
  s_add_u32 m0, s16, 8192
  s_add_u32 s29, s29, 262144
  buffer_load_dwordx4 v10, s[52:55], s43 offen lds
  s_add_u32 s43, s43, 88064
  s_add_u32 s16, s16, 16384
  s_and_b32 s16, s16, 0x1ffff
  s_add_u32 s65, s84, 2048
  buffer_load_dwordx4 v[112:115], v2, s[56:59], s65 offen sc1
  s_add_u32 s65, s84, 18432
  buffer_load_dwordx4 v[116:119], v2, s[56:59], s65 offen sc1
  s_add_u32 s65, s84, 3072
  buffer_load_dwordx4 v[120:123], v2, s[56:59], s65 offen sc1
  s_add_u32 s65, s84, 19456
  buffer_load_dwordx4 v[124:127], v2, s[56:59], s65 offen sc1
  v_mfma_f32_16x16x32_bf16 v[172:175], v[40:43], v[92:95], v[172:175]
  v_mfma_f32_16x16x32_bf16 v[176:179], v[80:83], v[44:47], v[176:179]
  v_mfma_f32_16x16x32_bf16 v[180:183], v[84:87], v[44:47], v[180:183]
  v_mfma_f32_16x16x32_bf16 v[184:187], v[44:47], v[88:91], v[184:187]
  v_mfma_f32_16x16x32_bf16 v[188:191], v[44:47], v[92:95], v[188:191]
  v_mfma_f32_16x16x32_bf16 v[192:195], v[80:83], v[48:51], v[192:195]
  v_mfma_f32_16x16x32_bf16 v[196:199], v[84:87], v[48:51], v[196:199]
  v_mfma_f32_16x16x32_bf16 v[200:203], v[48:51], v[88:91], v[200:203]
  v_mfma_f32_16x16x32_bf16 v[204:207], v[48:51], v[92:95], v[204:207]
  v_mfma_f32_16x16x32_bf16 v[208:211], v[80:83], v[52:55], v[208:211]
  v_mfma_f32_16x16x32_bf16 v[212:215], v[84:87], v[52:55], v[212:215]
  v_mfma_f32_16x16x32_bf16 v[216:219], v[52:55], v[88:91], v[216:219]
  v_mfma_f32_16x16x32_bf16 v[220:223], v[52:55], v[92:95], v[220:223]
  v_mfma_f32_16x16x32_bf16 v[224:227], v[80:83], v[56:59], v[224:227]
  v_mfma_f32_16x16x32_bf16 v[228:231], v[84:87], v[56:59], v[228:231]
  v_mfma_f32_16x16x32_bf16 v[232:235], v[56:59], v[88:91], v[232:235]
  v_mfma_f32_16x16x32_bf16 v[236:239], v[56:59], v[92:95], v[236:239]
  v_mfma_f32_16x16x32_bf16 v[240:243], v[80:83], v[60:63], v[240:243]
  v_mfma_f32_16x16x32_bf16 v[244:247], v[84:87], v[60:63], v[244:247]
  v_mfma_f32_16x16x32_bf16 v[248:251], v[60:63], v[88:91], v[248:251]
  v_mfma_f32_16x16x32_bf16 v[252:255], v[60:63], v[92:95], v[252:255]
  s_waitcnt lgkmcnt(0)
  s_nop 4
  v_cvt_pk_bf16_f32 v128, v128, v129
  v_cvt_pk_bf16_f32 v129, v130, v131
  v_cvt_pk_bf16_f32 v130, v132, v133
  v_cvt_pk_bf16_f32 v131, v134, v135
  v_cvt_pk_bf16_f32 v132, v144, v145
  v_cvt_pk_bf16_f32 v133, v146, v147
  v_cvt_pk_bf16_f32 v134, v148, v149
  v_cvt_pk_bf16_f32 v135, v150, v151
  v_cvt_pk_bf16_f32 v136, v136, v137
  v_cvt_pk_bf16_f32 v137, v138, v139
  v_cvt_pk_bf16_f32 v138, v152, v153
  v_cvt_pk_bf16_f32 v139, v154, v155
  v_cvt_pk_bf16_f32 v140, v140, v141
  v_cvt_pk_bf16_f32 v141, v142, v143
  v_cvt_pk_bf16_f32 v142, v156, v157
  v_cvt_pk_bf16_f32 v143, v158, v159
  v_cvt_pk_bf16_f32 v144, v160, v161
  v_cvt_pk_bf16_f32 v145, v162, v163
  v_cvt_pk_bf16_f32 v146, v164, v165
  v_cvt_pk_bf16_f32 v147, v166, v167
  v_cvt_pk_bf16_f32 v148, v176, v177
  v_cvt_pk_bf16_f32 v149, v178, v179
  v_cvt_pk_bf16_f32 v150, v180, v181
  v_cvt_pk_bf16_f32 v151, v182, v183
  v_cvt_pk_bf16_f32 v152, v168, v169
  v_cvt_pk_bf16_f32 v153, v170, v171
  v_cvt_pk_bf16_f32 v154, v184, v185
  v_cvt_pk_bf16_f32 v155, v186, v187
  v_cvt_pk_bf16_f32 v156, v172, v173
  v_cvt_pk_bf16_f32 v157, v174, v175
  v_cvt_pk_bf16_f32 v158, v188, v189
  v_cvt_pk_bf16_f32 v159, v190, v191
  v_cvt_pk_bf16_f32 v160, v192, v193
  v_cvt_pk_bf16_f32 v161, v194, v195
  v_cvt_pk_bf16_f32 v162, v196, v197
  v_cvt_pk_bf16_f32 v163, v198, v199
  v_cvt_pk_bf16_f32 v164, v208, v209
  v_cvt_pk_bf16_f32 v165, v210, v211
  v_cvt_pk_bf16_f32 v166, v212, v213
  v_cvt_pk_bf16_f32 v167, v214, v215
  v_cvt_pk_bf16_f32 v168, v200, v201
  v_cvt_pk_bf16_f32 v169, v202, v203
  v_cvt_pk_bf16_f32 v170, v216, v217
  v_cvt_pk_bf16_f32 v171, v218, v219
  v_cvt_pk_bf16_f32 v172, v204, v205
  v_cvt_pk_bf16_f32 v173, v206, v207
  v_cvt_pk_bf16_f32 v174, v220, v221
  v_cvt_pk_bf16_f32 v175, v222, v223
  v_cvt_pk_bf16_f32 v176, v224, v225
  v_cvt_pk_bf16_f32 v177, v226, v227
  v_cvt_pk_bf16_f32 v178, v228, v229
  v_cvt_pk_bf16_f32 v179, v230, v231
  v_cvt_pk_bf16_f32 v180, v240, v241
  v_cvt_pk_bf16_f32 v181, v242, v243
  v_cvt_pk_bf16_f32 v182, v244, v245
  v_cvt_pk_bf16_f32 v183, v246, v247
  v_cvt_pk_bf16_f32 v184, v232, v233
  v_cvt_pk_bf16_f32 v185, v234, v235
  v_cvt_pk_bf16_f32 v186, v248, v249
  v_cvt_pk_bf16_f32 v187, v250, v251
  v_cvt_pk_bf16_f32 v188, v236, v237
  v_cvt_pk_bf16_f32 v189, v238, v239
  v_cvt_pk_bf16_f32 v190, v252, v253
  v_cvt_pk_bf16_f32 v191, v254, v255
  v_lshrrev_b32 v17, 4, v1
  v_bfe_u32 v19, v1, 2, 2
  v_and_b32 v20, 3, v1
  v_and_b32 v21, 1, v17
  v_lshlrev_b32 v22, 6, v19
  v_lshl_add_u32 v22, v20, 3, v22
  v_lshl_add_u32 v22, v21, 5, v22
  v_lshl_add_u32 v3, v17, 11, v22
  v_xor_b32 v4, 32, v3
  v_lshl_add_u32 v5, v17, 10, v22
  v_add_u32 v5, 8192, v5
  v_xor_b32 v6, 32, v5
  v_mov_b32 v40, 0
  v_mov_b32 v41, 0
  v_mov_b32 v42, 0
  v_mov_b32 v43, 0
  v_mov_b32 v44, 0
  v_mov_b32 v45, 0
  v_mov_b32 v46, 0
  v_mov_b32 v47, 0
  v_mov_b32 v48, 0
  v_mov_b32 v49, 0
  v_mov_b32 v50, 0
  v_mov_b32 v51, 0
  v_mov_b32 v52, 0
  v_mov_b32 v53, 0
  v_mov_b32 v54, 0
  v_mov_b32 v55, 0
  v_mov_b32 v56, 0
  v_mov_b32 v57, 0
  v_mov_b32 v58, 0
  v_mov_b32 v59, 0
  v_mov_b32 v60, 0
  v_mov_b32 v61, 0
  v_mov_b32 v62, 0
  v_mov_b32 v63, 0
  v_mov_b32 v64, 0
  v_mov_b32 v65, 0
  v_mov_b32 v66, 0
  v_mov_b32 v67, 0
  v_mov_b32 v68, 0
  v_mov_b32 v69, 0
  v_mov_b32 v70, 0
  v_mov_b32 v71, 0
  v_mov_b32 v72, 0
  v_mov_b32 v73, 0
  v_mov_b32 v74, 0
  v_mov_b32 v75, 0
  v_mov_b32 v76, 0
  v_mov_b32 v77, 0
  v_mov_b32 v78, 0
  v_mov_b32 v79, 0
  v_mov_b32 v80, 0
  v_mov_b32 v81, 0
  v_mov_b32 v82, 0
  v_mov_b32 v83, 0
  v_mov_b32 v84, 0
  v_mov_b32 v85, 0
  v_mov_b32 v86, 0
  v_mov_b32 v87, 0
  v_mov_b32 v192, 0
  v_mov_b32 v193, 0
  v_mov_b32 v194, 0
  v_mov_b32 v195, 0
  v_mov_b32 v196, 0
  v_mov_b32 v197, 0
  v_mov_b32 v198, 0
  v_mov_b32 v199, 0
  v_mov_b32 v200, 0
  v_mov_b32 v201, 0
  v_mov_b32 v202, 0
  v_mov_b32 v203, 0
  v_mov_b32 v204, 0
  v_mov_b32 v205, 0
  v_mov_b32 v206, 0
  v_mov_b32 v207, 0
  v_mov_b32 v208, 0
  v_mov_b32 v209, 0
  v_mov_b32 v210, 0
  v_mov_b32 v211, 0
  v_mov_b32 v212, 0
  v_mov_b32 v213, 0
  v_mov_b32 v214, 0
  v_mov_b32 v215, 0
  v_mov_b32 v216, 0
  v_mov_b32 v217, 0
  v_mov_b32 v218, 0
  v_mov_b32 v219, 0
  v_mov_b32 v220, 0
  v_mov_b32 v221, 0
  v_mov_b32 v222, 0
  v_mov_b32 v223, 0
  v_mov_b32 v224, 0
  v_mov_b32 v225, 0
  v_mov_b32 v226, 0
  v_mov_b32 v227, 0
  v_mov_b32 v228, 0
  v_mov_b32 v229, 0
  v_mov_b32 v230, 0
  v_mov_b32 v231, 0
  v_mov_b32 v232, 0
  v_mov_b32 v233, 0
  v_mov_b32 v234, 0
  v_mov_b32 v235, 0
  v_mov_b32 v236, 0
  v_mov_b32 v237, 0
  v_mov_b32 v238, 0
  v_mov_b32 v239, 0
  v_mov_b32 v240, 0
  v_mov_b32 v241, 0
  v_mov_b32 v242, 0
  v_mov_b32 v243, 0
  v_mov_b32 v244, 0
  v_mov_b32 v245, 0
  v_mov_b32 v246, 0
  v_mov_b32 v247, 0
  v_mov_b32 v248, 0
  v_mov_b32 v249, 0
  v_mov_b32 v250, 0
  v_mov_b32 v251, 0
  v_mov_b32 v252, 0
  v_mov_b32 v253, 0
  v_mov_b32 v254, 0
  v_mov_b32 v255, 0
  s_waitcnt vmcnt(16)
  s_barrier
  ds_read_b64_tr_b16 v[16:17], v3 offset:0
  ds_read_b64_tr_b16 v[18:19], v3 offset:1024
  ds_read_b64_tr_b16 v[20:21], v4 offset:0
  ds_read_b64_tr_b16 v[22:23], v4 offset:1024
  ds_read_b64_tr_b16 v[24:25], v3 offset:256
  ds_read_b64_tr_b16 v[26:27], v3 offset:1280
  ds_read_b64_tr_b16 v[28:29], v4 offset:256
  ds_read_b64_tr_b16 v[30:31], v4 offset:1280
  ds_read_b64_tr_b16 v[32:33], v3 offset:512
  ds_read_b64_tr_b16 v[34:35], v3 offset:1536
  ds_read_b64_tr_b16 v[36:37], v4 offset:512
  ds_read_b64_tr_b16 v[38:39], v4 offset:1536
  ds_read_b64_tr_b16 v[88:89], v3 offset:768
  ds_read_b64_tr_b16 v[90:91], v3 offset:1792
  ds_read_b64_tr_b16 v[92:93], v4 offset:768
  ds_read_b64_tr_b16 v[94:95], v4 offset:1792
  s_waitcnt vmcnt(10)
  s_waitcnt lgkmcnt(14)
  v_mfma_f32_16x16x32_bf16 v[192:195], v[16:19], v[96:99], v[192:195]
  v_mfma_f32_16x16x32_bf16 v[196:199], v[16:19], v[100:103], v[196:199]
  ds_read_b64_tr_b16 v[16:17], v5 offset:0
  ds_read_b64_tr_b16 v[18:19], v5 offset:512
  s_waitcnt lgkmcnt(14)
  v_mfma_f32_16x16x32_bf16 v[200:203], v[20:23], v[96:99], v[200:203]
  v_mfma_f32_16x16x32_bf16 v[204:207], v[20:23], v[100:103], v[204:207]
  ds_read_b64_tr_b16 v[20:21], v5 offset:4096
  ds_read_b64_tr_b16 v[22:23], v5 offset:4608
  s_waitcnt lgkmcnt(14)
  v_mfma_f32_16x16x32_bf16 v[208:211], v[24:27], v[96:99], v[208:211]
  v_mfma_f32_16x16x32_bf16 v[212:215], v[24:27], v[100:103], v[212:215]
  ds_read_b64_tr_b16 v[24:25], v6 offset:0
  ds_read_b64_tr_b16 v[26:27], v6 offset:512
  buffer_store_dwordx4 v[128:131], v2, s[56:59], s72 offen sc1
  s_add_u32 s72, s72, 4096
  s_waitcnt lgkmcnt(14)
  v_mfma_f32_16x16x32_bf16 v[216:219], v[28:31], v[96:99], v[216:219]
  v_mfma_f32_16x16x32_bf16 v[220:223], v[28:31], v[100:103], v[220:223]
  ds_read_b64_tr_b16 v[28:29], v6 offset:4096
  ds_read_b64_tr_b16 v[30:31], v6 offset:4608
  s_waitcnt lgkmcnt(14)
  v_mfma_f32_16x16x32_bf16 v[224:227], v[32:35], v[96:99], v[224:227]
  v_mfma_f32_16x16x32_bf16 v[228:231], v[32:35], v[100:103], v[228:231]
  ds_read_b64_tr_b16 v[32:33], v5 offset:256
  ds_read_b64_tr_b16 v[34:35], v5 offset:768
  s_waitcnt lgkmcnt(14)
  v_mfma_f32_16x16x32_bf16 v[232:235], v[36:39], v[96:99], v[232:235]
  v_mfma_f32_16x16x32_bf16 v[236:239], v[36:39], v[100:103], v[236:239]
  ds_read_b64_tr_b16 v[36:37], v5 offset:4352
  ds_read_b64_tr_b16 v[38:39], v5 offset:4864
  s_waitcnt lgkmcnt(14)
  v_mfma_f32_16x16x32_bf16 v[240:243], v[88:91], v[96:99], v[240:243]
  v_mfma_f32_16x16x32_bf16 v[244:247], v[88:91], v[100:103], v[244:247]
  ds_read_b64_tr_b16 v[88:89], v3 offset:16384
  ds_read_b64_tr_b16 v[90:91], v3 offset:17408
  s_waitcnt lgkmcnt(14)
  v_mfma_f32_16x16x32_bf16 v[248:251], v[92:95], v[96:99], v[248:251]
  v_mfma_f32_16x16x32_bf16 v[252:255], v[92:95], v[100:103], v[252:255]
  ds_read_b64_tr_b16 v[92:93], v4 offset:16384
  ds_read_b64_tr_b16 v[94:95], v4 offset:17408
  buffer_store_dwordx4 v[132:135], v2, s[56:59], s72 offen sc1
  s_add_u32 s72, s72, 4096
  s_waitcnt lgkmcnt(14)
  v_mfma_f32_16x16x32_bf16 v[40:43], v[16:19], v[96:99], v[40:43]
  v_mfma_f32_16x16x32_bf16 v[44:47], v[16:19], v[100:103], v[44:47]
  ds_read_b64_tr_b16 v[16:17], v3 offset:16640
  ds_read_b64_tr_b16 v[18:19], v3 offset:17664
  s_waitcnt lgkmcnt(14)
  v_mfma_f32_16x16x32_bf16 v[48:51], v[20:23], v[96:99], v[48:51]
  v_mfma_f32_16x16x32_bf16 v[52:55], v[20:23], v[100:103], v[52:55]
  ds_read_b64_tr_b16 v[20:21], v4 offset:16640
  ds_read_b64_tr_b16 v[22:23], v4 offset:17664
  s_waitcnt lgkmcnt(14)
  v_mfma_f32_16x16x32_bf16 v[56:59], v[24:27], v[96:99], v[56:59]
  v_mfma_f32_16x16x32_bf16 v[60:63], v[24:27], v[100:103], v[60:63]
  ds_read_b64_tr_b16 v[24:25], v3 offset:16896
  ds_read_b64_tr_b16 v[26:27], v3 offset:17920
  s_waitcnt lgkmcnt(14)
  v_mfma_f32_16x16x32_bf16 v[64:67], v[28:31], v[96:99], v[64:67]
  v_mfma_f32_16x16x32_bf16 v[68:71], v[28:31], v[100:103], v[68:71]
  ds_read_b64_tr_b16 v[28:29], v4 offset:16896
  ds_read_b64_tr_b16 v[30:31], v4 offset:17920
  s_waitcnt lgkmcnt(14)
  v_mfma_f32_16x16x32_bf16 v[72:75], v[32:35], v[96:99], v[72:75]
  v_mfma_f32_16x16x32_bf16 v[76:79], v[32:35], v[100:103], v[76:79]
  ds_read_b64_tr_b16 v[32:33], v3 offset:17152
  ds_read_b64_tr_b16 v[34:35], v3 offset:18176
  s_waitcnt lgkmcnt(14)
  v_mfma_f32_16x16x32_bf16 v[80:83], v[36:39], v[96:99], v[80:83]
  v_mfma_f32_16x16x32_bf16 v[84:87], v[36:39], v[100:103], v[84:87]
  ds_read_b64_tr_b16 v[36:37], v4 offset:17152
  ds_read_b64_tr_b16 v[38:39], v4 offset:18176
  s_add_u32 s65, s84, 4096
  buffer_load_dwordx4 v[96:99], v2, s[56:59], s65 offen sc1
  s_add_u32 s65, s84, 20480
  buffer_load_dwordx4 v[100:103], v2, s[56:59], s65 offen sc1
  s_waitcnt vmcnt(12)
  s_waitcnt lgkmcnt(14)
  v_mfma_f32_16x16x32_bf16 v[192:195], v[88:91], v[104:107], v[192:195]
  v_mfma_f32_16x16x32_bf16 v[196:199], v[88:91], v[108:111], v[196:199]
  ds_read_b64_tr_b16 v[88:89], v5 offset:16384
  ds_read_b64_tr_b16 v[90:91], v5 offset:16896
  s_waitcnt lgkmcnt(14)
  v_mfma_f32_16x16x32_bf16 v[200:203], v[92:95], v[104:107], v[200:203]
  v_mfma_f32_16x16x32_bf16 v[204:207], v[92:95], v[108:111], v[204:207]
  ds_read_b64_tr_b16 v[92:93], v5 offset:20480
  ds_read_b64_tr_b16 v[94:95], v5 offset:20992
  s_waitcnt lgkmcnt(14)
  v_mfma_f32_16x16x32_bf16 v[208:211], v[16:19], v[104:107], v[208:211]
  v_mfma_f32_16x16x32_bf16 v[212:215], v[16:19], v[108:111], v[212:215]
  ds_read_b64_tr_b16 v[16:17], v6 offset:16384
  ds_read_b64_tr_b16 v[18:19], v6 offset:16896
  buffer_store_dwordx4 v[136:139], v2, s[56:59], s73 offen sc1
  s_waitcnt lgkmcnt(14)
  v_mfma_f32_16x16x32_bf16 v[216:219], v[20:23], v[104:107], v[216:219]
  v_mfma_f32_16x16x32_bf16 v[220:223], v[20:23], v[108:111], v[220:223]
  ds_read_b64_tr_b16 v[20:21], v6 offset:20480
  ds_read_b64_tr_b16 v[22:23], v6 offset:20992
  s_waitcnt lgkmcnt(14)
  v_mfma_f32_16x16x32_bf16 v[224:227], v[24:27], v[104:107], v[224:227]
  v_mfma_f32_16x16x32_bf16 v[228:231], v[24:27], v[108:111], v[228:231]
  ds_read_b64_tr_b16 v[24:25], v5 offset:16640
  ds_read_b64_tr_b16 v[26:27], v5 offset:17152
  s_waitcnt lgkmcnt(14)
  v_mfma_f32_16x16x32_bf16 v[232:235], v[28:31], v[104:107], v[232:235]
  v_mfma_f32_16x16x32_bf16 v[236:239], v[28:31], v[108:111], v[236:239]
  ds_read_b64_tr_b16 v[28:29], v5 offset:20736
  ds_read_b64_tr_b16 v[30:31], v5 offset:21248
  s_waitcnt lgkmcnt(14)
  v_mfma_f32_16x16x32_bf16 v[240:243], v[32:35], v[104:107], v[240:243]
  v_mfma_f32_16x16x32_bf16 v[244:247], v[32:35], v[108:111], v[244:247]
  s_barrier
  ds_read_b64_tr_b16 v[32:33], v3 offset:32768
  ds_read_b64_tr_b16 v[34:35], v3 offset:33792
  s_waitcnt lgkmcnt(14)
  v_mfma_f32_16x16x32_bf16 v[248:251], v[36:39], v[104:107], v[248:251]
  v_mfma_f32_16x16x32_bf16 v[252:255], v[36:39], v[108:111], v[252:255]
  ds_read_b64_tr_b16 v[36:37], v4 offset:32768
  ds_read_b64_tr_b16 v[38:39], v4 offset:33792
  s_waitcnt lgkmcnt(14)
  v_mfma_f32_16x16x32_bf16 v[40:43], v[88:91], v[104:107], v[40:43]
  v_mfma_f32_16x16x32_bf16 v[44:47], v[88:91], v[108:111], v[44:47]
  ds_read_b64_tr_b16 v[88:89], v3 offset:33024
  ds_read_b64_tr_b16 v[90:91], v3 offset:34048
  s_waitcnt lgkmcnt(14)
  v_mfma_f32_16x16x32_bf16 v[48:51], v[92:95], v[104:107], v[48:51]
  v_mfma_f32_16x16x32_bf16 v[52:55], v[92:95], v[108:111], v[52:55]
  ds_read_b64_tr_b16 v[92:93], v4 offset:33024
  ds_read_b64_tr_b16 v[94:95], v4 offset:34048
  s_waitcnt lgkmcnt(14)
  v_mfma_f32_16x16x32_bf16 v[56:59], v[16:19], v[104:107], v[56:59]
  v_mfma_f32_16x16x32_bf16 v[60:63], v[16:19], v[108:111], v[60:63]
  ds_read_b64_tr_b16 v[16:17], v3 offset:33280
  ds_read_b64_tr_b16 v[18:19], v3 offset:34304
  s_waitcnt lgkmcnt(14)
  v_mfma_f32_16x16x32_bf16 v[64:67], v[20:23], v[104:107], v[64:67]
  v_mfma_f32_16x16x32_bf16 v[68:71], v[20:23], v[108:111], v[68:71]
  ds_read_b64_tr_b16 v[20:21], v4 offset:33280
  ds_read_b64_tr_b16 v[22:23], v4 offset:34304
  s_waitcnt lgkmcnt(14)
  v_mfma_f32_16x16x32_bf16 v[72:75], v[24:27], v[104:107], v[72:75]
  v_mfma_f32_16x16x32_bf16 v[76:79], v[24:27], v[108:111], v[76:79]
  ds_read_b64_tr_b16 v[24:25], v3 offset:33536
  ds_read_b64_tr_b16 v[26:27], v3 offset:34560
  s_waitcnt lgkmcnt(14)
  v_mfma_f32_16x16x32_bf16 v[80:83], v[28:31], v[104:107], v[80:83]
  v_mfma_f32_16x16x32_bf16 v[84:87], v[28:31], v[108:111], v[84:87]
  ds_read_b64_tr_b16 v[28:29], v4 offset:33536
  ds_read_b64_tr_b16 v[30:31], v4 offset:34560
  s_add_u32 s65, s84, 5120
  buffer_load_dwordx4 v[104:107], v2, s[56:59], s65 offen sc1
  s_add_u32 s65, s84, 21504
  buffer_load_dwordx4 v[108:111], v2, s[56:59], s65 offen sc1
  s_waitcnt vmcnt(9)
  s_waitcnt lgkmcnt(14)
  v_mfma_f32_16x16x32_bf16 v[192:195], v[32:35], v[112:115], v[192:195]
  v_mfma_f32_16x16x32_bf16 v[196:199], v[32:35], v[116:119], v[196:199]
  ds_read_b64_tr_b16 v[32:33], v5 offset:32768
  ds_read_b64_tr_b16 v[34:35], v5 offset:33280
  s_waitcnt lgkmcnt(14)
  v_mfma_f32_16x16x32_bf16 v[200:203], v[36:39], v[112:115], v[200:203]
  v_mfma_f32_16x16x32_bf16 v[204:207], v[36:39], v[116:119], v[204:207]
  ds_read_b64_tr_b16 v[36:37], v5 offset:36864
  ds_read_b64_tr_b16 v[38:39], v5 offset:37376
  s_waitcnt lgkmcnt(14)
  v_mfma_f32_16x16x32_bf16 v[208:211], v[88:91], v[112:115], v[208:211]
  v_mfma_f32_16x16x32_bf16 v[212:215], v[88:91], v[116:119], v[212:215]
  ds_read_b64_tr_b16 v[88:89], v6 offset:32768
  ds_read_b64_tr_b16 v[90:91], v6 offset:33280
  buffer_store_dwordx4 v[140:143], v2, s[56:59], s73 offen offset:1024 sc1
  s_add_u32 s73, s73, 8192
  s_waitcnt lgkmcnt(14)
  v_mfma_f32_16x16x32_bf16 v[216:219], v[92:95], v[112:115], v[216:219]
  v_mfma_f32_16x16x32_bf16 v[220:223], v[92:95], v[116:119], v[220:223]
  ds_read_b64_tr_b16 v[92:93], v6 offset:36864
  ds_read_b64_tr_b16 v[94:95], v6 offset:37376
  s_waitcnt lgkmcnt(14)
  v_mfma_f32_16x16x32_bf16 v[224:227], v[16:19], v[112:115], v[224:227]
  v_mfma_f32_16x16x32_bf16 v[228:231], v[16:19], v[116:119], v[228:231]
  ds_read_b64_tr_b16 v[16:17], v5 offset:33024
  ds_read_b64_tr_b16 v[18:19], v5 offset:33536
  s_waitcnt lgkmcnt(14)
  v_mfma_f32_16x16x32_bf16 v[232:235], v[20:23], v[112:115], v[232:235]
  v_mfma_f32_16x16x32_bf16 v[236:239], v[20:23], v[116:119], v[236:239]
  ds_read_b64_tr_b16 v[20:21], v5 offset:37120
  ds_read_b64_tr_b16 v[22:23], v5 offset:37632
  s_waitcnt lgkmcnt(14)
  v_mfma_f32_16x16x32_bf16 v[240:243], v[24:27], v[112:115], v[240:243]
  v_mfma_f32_16x16x32_bf16 v[244:247], v[24:27], v[116:119], v[244:247]
  ds_read_b64_tr_b16 v[24:25], v3 offset:49152
  ds_read_b64_tr_b16 v[26:27], v3 offset:50176
  s_waitcnt lgkmcnt(14)
  v_mfma_f32_16x16x32_bf16 v[248:251], v[28:31], v[112:115], v[248:251]
  v_mfma_f32_16x16x32_bf16 v[252:255], v[28:31], v[116:119], v[252:255]
  ds_read_b64_tr_b16 v[28:29], v4 offset:49152
  ds_read_b64_tr_b16 v[30:31], v4 offset:50176
  buffer_store_dwordx4 v[144:147], v2, s[56:59], s72 offen sc1
  s_add_u32 s72, s72, 4096
  s_waitcnt lgkmcnt(14)
  v_mfma_f32_16x16x32_bf16 v[40:43], v[32:35], v[112:115], v[40:43]
  v_mfma_f32_16x16x32_bf16 v[44:47], v[32:35], v[116:119], v[44:47]
  ds_read_b64_tr_b16 v[32:33], v3 offset:49408
  ds_read_b64_tr_b16 v[34:35], v3 offset:50432
  s_waitcnt lgkmcnt(14)
  v_mfma_f32_16x16x32_bf16 v[48:51], v[36:39], v[112:115], v[48:51]
  v_mfma_f32_16x16x32_bf16 v[52:55], v[36:39], v[116:119], v[52:55]
  ds_read_b64_tr_b16 v[36:37], v4 offset:49408
  ds_read_b64_tr_b16 v[38:39], v4 offset:50432
  s_waitcnt lgkmcnt(14)
  v_mfma_f32_16x16x32_bf16 v[56:59], v[88:91], v[112:115], v[56:59]
  v_mfma_f32_16x16x32_bf16 v[60:63], v[88:91], v[116:119], v[60:63]
  ds_read_b64_tr_b16 v[88:89], v3 offset:49664
  ds_read_b64_tr_b16 v[90:91], v3 offset:50688
  s_waitcnt lgkmcnt(14)
  v_mfma_f32_16x16x32_bf16 v[64:67], v[92:95], v[112:115], v[64:67]
  v_mfma_f32_16x16x32_bf16 v[68:71], v[92:95], v[116:119], v[68:71]
  ds_read_b64_tr_b16 v[92:93], v4 offset:49664
  ds_read_b64_tr_b16 v[94:95], v4 offset:50688
  s_waitcnt lgkmcnt(14)
  v_mfma_f32_16x16x32_bf16 v[72:75], v[16:19], v[112:115], v[72:75]
  v_mfma_f32_16x16x32_bf16 v[76:79], v[16:19], v[116:119], v[76:79]
  ds_read_b64_tr_b16 v[16:17], v3 offset:49920
  ds_read_b64_tr_b16 v[18:19], v3 offset:50944
  s_waitcnt lgkmcnt(14)
  v_mfma_f32_16x16x32_bf16 v[80:83], v[20:23], v[112:115], v[80:83]
  v_mfma_f32_16x16x32_bf16 v[84:87], v[20:23], v[116:119], v[84:87]
  ds_read_b64_tr_b16 v[20:21], v4 offset:49920
  ds_read_b64_tr_b16 v[22:23], v4 offset:50944
  s_add_u32 s65, s84, 6144
  buffer_load_dwordx4 v[112:115], v2, s[56:59], s65 offen sc1
  s_add_u32 s65, s84, 22528
  buffer_load_dwordx4 v[116:119], v2, s[56:59], s65 offen sc1
  s_waitcnt vmcnt(11)
  s_waitcnt lgkmcnt(14)
  v_mfma_f32_16x16x32_bf16 v[192:195], v[24:27], v[120:123], v[192:195]
  v_mfma_f32_16x16x32_bf16 v[196:199], v[24:27], v[124:127], v[196:199]
  ds_read_b64_tr_b16 v[24:25], v5 offset:49152
  ds_read_b64_tr_b16 v[26:27], v5 offset:49664
  s_waitcnt lgkmcnt(14)
  v_mfma_f32_16x16x32_bf16 v[200:203], v[28:31], v[120:123], v[200:203]
  v_mfma_f32_16x16x32_bf16 v[204:207], v[28:31], v[124:127], v[204:207]
  ds_read_b64_tr_b16 v[28:29], v5 offset:53248
  ds_read_b64_tr_b16 v[30:31], v5 offset:53760
  s_waitcnt lgkmcnt(14)
  v_mfma_f32_16x16x32_bf16 v[208:211], v[32:35], v[120:123], v[208:211]
  v_mfma_f32_16x16x32_bf16 v[212:215], v[32:35], v[124:127], v[212:215]
  ds_read_b64_tr_b16 v[32:33], v6 offset:49152
  ds_read_b64_tr_b16 v[34:35], v6 offset:49664
  buffer_store_dwordx4 v[148:151], v2, s[56:59], s72 offen sc1
  s_add_u32 s72, s72, 4096
  s_waitcnt lgkmcnt(14)
  v_mfma_f32_16x16x32_bf16 v[216:219], v[36:39], v[120:123], v[216:219]
  v_mfma_f32_16x16x32_bf16 v[220:223], v[36:39], v[124:127], v[220:223]
  ds_read_b64_tr_b16 v[36:37], v6 offset:53248
  ds_read_b64_tr_b16 v[38:39], v6 offset:53760
  s_waitcnt lgkmcnt(14)
  v_mfma_f32_16x16x32_bf16 v[224:227], v[88:91], v[120:123], v[224:227]
  v_mfma_f32_16x16x32_bf16 v[228:231], v[88:91], v[124:127], v[228:231]
  ds_read_b64_tr_b16 v[88:89], v5 offset:49408
  ds_read_b64_tr_b16 v[90:91], v5 offset:49920
  s_waitcnt lgkmcnt(14)
  v_mfma_f32_16x16x32_bf16 v[232:235], v[92:95], v[120:123], v[232:235]
  v_mfma_f32_16x16x32_bf16 v[236:239], v[92:95], v[124:127], v[236:239]
  ds_read_b64_tr_b16 v[92:93], v5 offset:53504
  ds_read_b64_tr_b16 v[94:95], v5 offset:54016
  s_waitcnt lgkmcnt(14)
  v_mfma_f32_16x16x32_bf16 v[240:243], v[16:19], v[120:123], v[240:243]
  v_mfma_f32_16x16x32_bf16 v[244:247], v[16:19], v[124:127], v[244:247]
  s_barrier
  v_xor_b32 v3, 65536, v3
  v_xor_b32 v4, 65536, v4
  v_xor_b32 v5, 65536, v5
  v_xor_b32 v6, 65536, v6
  ds_read_b64_tr_b16 v[16:17], v3 offset:0
  ds_read_b64_tr_b16 v[18:19], v3 offset:1024
  s_waitcnt lgkmcnt(14)
  v_mfma_f32_16x16x32_bf16 v[248:251], v[20:23], v[120:123], v[248:251]
  v_mfma_f32_16x16x32_bf16 v[252:255], v[20:23], v[124:127], v[252:255]
  ds_read_b64_tr_b16 v[20:21], v4 offset:0
  ds_read_b64_tr_b16 v[22:23], v4 offset:1024
  s_waitcnt lgkmcnt(14)
  v_mfma_f32_16x16x32_bf16 v[40:43], v[24:27], v[120:123], v[40:43]
  v_mfma_f32_16x16x32_bf16 v[44:47], v[24:27], v[124:127], v[44:47]
  ds_read_b64_tr_b16 v[24:25], v3 offset:256
  ds_read_b64_tr_b16 v[26:27], v3 offset:1280
  s_waitcnt lgkmcnt(14)
  v_mfma_f32_16x16x32_bf16 v[48:51], v[28:31], v[120:123], v[48:51]
  v_mfma_f32_16x16x32_bf16 v[52:55], v[28:31], v[124:127], v[52:55]
  ds_read_b64_tr_b16 v[28:29], v4 offset:256
  ds_read_b64_tr_b16 v[30:31], v4 offset:1280
  s_mov_b32 m0, s16
  s_nop 0
  buffer_load_dwordx4 v9, s[12:15], s29 offen lds
  s_waitcnt lgkmcnt(14)
  v_mfma_f32_16x16x32_bf16 v[56:59], v[32:35], v[120:123], v[56:59]
  v_mfma_f32_16x16x32_bf16 v[60:63], v[32:35], v[124:127], v[60:63]
  ds_read_b64_tr_b16 v[32:33], v3 offset:512
  ds_read_b64_tr_b16 v[34:35], v3 offset:1536
  s_add_u32 m0, s16, 8192
  s_add_u32 s29, s29, 262144
  buffer_load_dwordx4 v10, s[52:55], s43 offen lds
  s_add_u32 s43, s43, 88064
  s_add_u32 s16, s16, 16384
  s_and_b32 s16, s16, 0x1ffff
  s_waitcnt lgkmcnt(14)
  v_mfma_f32_16x16x32_bf16 v[64:67], v[36:39], v[120:123], v[64:67]
  v_mfma_f32_16x16x32_bf16 v[68:71], v[36:39], v[124:127], v[68:71]
  ds_read_b64_tr_b16 v[36:37], v4 offset:512
  ds_read_b64_tr_b16 v[38:39], v4 offset:1536
  s_mov_b32 m0, s16
  s_nop 0
  buffer_load_dwordx4 v9, s[12:15], s29 offen lds
  s_waitcnt lgkmcnt(14)
  v_mfma_f32_16x16x32_bf16 v[72:75], v[88:91], v[120:123], v[72:75]
  v_mfma_f32_16x16x32_bf16 v[76:79], v[88:91], v[124:127], v[76:79]
  ds_read_b64_tr_b16 v[88:89], v3 offset:768
  ds_read_b64_tr_b16 v[90:91], v3 offset:1792
  s_add_u32 m0, s16, 8192
  s_add_u32 s29, s29, 262144
  buffer_load_dwordx4 v10, s[52:55], s43 offen lds
  s_add_u32 s43, s43, 88064
  s_add_u32 s16, s16, 16384
  s_and_b32 s16, s16, 0x1ffff
  s_waitcnt lgkmcnt(14)
  v_mfma_f32_16x16x32_bf16 v[80:83], v[92:95], v[120:123], v[80:83]
  v_mfma_f32_16x16x32_bf16 v[84:87], v[92:95], v[124:127], v[84:87]
  ds_read_b64_tr_b16 v[92:93], v4 offset:768
  ds_read_b64_tr_b16 v[94:95], v4 offset:1792
  s_add_u32 s65, s84, 7168
  buffer_load_dwordx4 v[120:123], v2, s[56:59], s65 offen sc1
  s_add_u32 s65, s84, 23552
  buffer_load_dwordx4 v[124:127], v2, s[56:59], s65 offen sc1
  s_waitcnt vmcnt(14)
  s_waitcnt lgkmcnt(14)
  v_mfma_f32_16x16x32_bf16 v[192:195], v[16:19], v[96:99], v[192:195]
  v_mfma_f32_16x16x32_bf16 v[196:199], v[16:19], v[100:103], v[196:199]
  ds_read_b64_tr_b16 v[16:17], v5 offset:0
  ds_read_b64_tr_b16 v[18:19], v5 offset:512
  s_waitcnt lgkmcnt(14)
  v_mfma_f32_16x16x32_bf16 v[200:203], v[20:23], v[96:99], v[200:203]
  v_mfma_f32_16x16x32_bf16 v[204:207], v[20:23], v[100:103], v[204:207]
  ds_read_b64_tr_b16 v[20:21], v5 offset:4096
  ds_read_b64_tr_b16 v[22:23], v5 offset:4608
  s_waitcnt lgkmcnt(14)
  v_mfma_f32_16x16x32_bf16 v[208:211], v[24:27], v[96:99], v[208:211]
  v_mfma_f32_16x16x32_bf16 v[212:215], v[24:27], v[100:103], v[212:215]
  ds_read_b64_tr_b16 v[24:25], v6 offset:0
  ds_read_b64_tr_b16 v[26:27], v6 offset:512
  buffer_store_dwordx4 v[152:155], v2, s[56:59], s73 offen sc1
  s_waitcnt lgkmcnt(14)
  v_mfma_f32_16x16x32_bf16 v[216:219], v[28:31], v[96:99], v[216:219]
  v_mfma_f32_16x16x32_bf16 v[220:223], v[28:31], v[100:103], v[220:223]
  ds_read_b64_tr_b16 v[28:29], v6 offset:4096
  ds_read_b64_tr_b16 v[30:31], v6 offset:4608
  s_waitcnt lgkmcnt(14)
  v_mfma_f32_16x16x32_bf16 v[224:227], v[32:35], v[96:99], v[224:227]
  v_mfma_f32_16x16x32_bf16 v[228:231], v[32:35], v[100:103], v[228:231]
  ds_read_b64_tr_b16 v[32:33], v5 offset:256
  ds_read_b64_tr_b16 v[34:35], v5 offset:768
  s_waitcnt lgkmcnt(14)
  v_mfma_f32_16x16x32_bf16 v[232:235], v[36:39], v[96:99], v[232:235]
  v_mfma_f32_16x16x32_bf16 v[236:239], v[36:39], v[100:103], v[236:239]
  ds_read_b64_tr_b16 v[36:37], v5 offset:4352
  ds_read_b64_tr_b16 v[38:39], v5 offset:4864
  s_waitcnt lgkmcnt(14)
  v_mfma_f32_16x16x32_bf16 v[240:243], v[88:91], v[96:99], v[240:243]
  v_mfma_f32_16x16x32_bf16 v[244:247], v[88:91], v[100:103], v[244:247]
  ds_read_b64_tr_b16 v[88:89], v3 offset:16384
  ds_read_b64_tr_b16 v[90:91], v3 offset:17408
  s_waitcnt lgkmcnt(14)
  v_mfma_f32_16x16x32_bf16 v[248:251], v[92:95], v[96:99], v[248:251]
  v_mfma_f32_16x16x32_bf16 v[252:255], v[92:95], v[100:103], v[252:255]
  ds_read_b64_tr_b16 v[92:93], v4 offset:16384
  ds_read_b64_tr_b16 v[94:95], v4 offset:17408
  buffer_store_dwordx4 v[156:159], v2, s[56:59], s73 offen offset:1024 sc1
  s_add_u32 s73, s73, 8192
  s_waitcnt lgkmcnt(14)
  v_mfma_f32_16x16x32_bf16 v[40:43], v[16:19], v[96:99], v[40:43]
  v_mfma_f32_16x16x32_bf16 v[44:47], v[16:19], v[100:103], v[44:47]
  ds_read_b64_tr_b16 v[16:17], v3 offset:16640
  ds_read_b64_tr_b16 v[18:19], v3 offset:17664
  s_waitcnt lgkmcnt(14)
  v_mfma_f32_16x16x32_bf16 v[48:51], v[20:23], v[96:99], v[48:51]
  v_mfma_f32_16x16x32_bf16 v[52:55], v[20:23], v[100:103], v[52:55]
  ds_read_b64_tr_b16 v[20:21], v4 offset:16640
  ds_read_b64_tr_b16 v[22:23], v4 offset:17664
  s_waitcnt lgkmcnt(14)
  v_mfma_f32_16x16x32_bf16 v[56:59], v[24:27], v[96:99], v[56:59]
  v_mfma_f32_16x16x32_bf16 v[60:63], v[24:27], v[100:103], v[60:63]
  ds_read_b64_tr_b16 v[24:25], v3 offset:16896
  ds_read_b64_tr_b16 v[26:27], v3 offset:17920
  s_waitcnt lgkmcnt(14)
  v_mfma_f32_16x16x32_bf16 v[64:67], v[28:31], v[96:99], v[64:67]
  v_mfma_f32_16x16x32_bf16 v[68:71], v[28:31], v[100:103], v[68:71]
  ds_read_b64_tr_b16 v[28:29], v4 offset:16896
  ds_read_b64_tr_b16 v[30:31], v4 offset:17920
  s_waitcnt lgkmcnt(14)
  v_mfma_f32_16x16x32_bf16 v[72:75], v[32:35], v[96:99], v[72:75]
  v_mfma_f32_16x16x32_bf16 v[76:79], v[32:35], v[100:103], v[76:79]
  ds_read_b64_tr_b16 v[32:33], v3 offset:17152
  ds_read_b64_tr_b16 v[34:35], v3 offset:18176
  s_waitcnt lgkmcnt(14)
  v_mfma_f32_16x16x32_bf16 v[80:83], v[36:39], v[96:99], v[80:83]
  v_mfma_f32_16x16x32_bf16 v[84:87], v[36:39], v[100:103], v[84:87]
  ds_read_b64_tr_b16 v[36:37], v4 offset:17152
  ds_read_b64_tr_b16 v[38:39], v4 offset:18176
  s_add_u32 s65, s84, 8192
  buffer_load_dwordx4 v[96:99], v2, s[56:59], s65 offen sc1
  s_add_u32 s65, s84, 24576
  buffer_load_dwordx4 v[100:103], v2, s[56:59], s65 offen sc1
  s_waitcnt vmcnt(15)
  s_waitcnt lgkmcnt(14)
  v_mfma_f32_16x16x32_bf16 v[192:195], v[88:91], v[104:107], v[192:195]
  v_mfma_f32_16x16x32_bf16 v[196:199], v[88:91], v[108:111], v[196:199]
  ds_read_b64_tr_b16 v[88:89], v5 offset:16384
  ds_read_b64_tr_b16 v[90:91], v5 offset:16896
  s_waitcnt lgkmcnt(14)
  v_mfma_f32_16x16x32_bf16 v[200:203], v[92:95], v[104:107], v[200:203]
  v_mfma_f32_16x16x32_bf16 v[204:207], v[92:95], v[108:111], v[204:207]
  ds_read_b64_tr_b16 v[92:93], v5 offset:20480
  ds_read_b64_tr_b16 v[94:95], v5 offset:20992
  s_waitcnt lgkmcnt(14)
  v_mfma_f32_16x16x32_bf16 v[208:211], v[16:19], v[104:107], v[208:211]
  v_mfma_f32_16x16x32_bf16 v[212:215], v[16:19], v[108:111], v[212:215]
  ds_read_b64_tr_b16 v[16:17], v6 offset:16384
  ds_read_b64_tr_b16 v[18:19], v6 offset:16896
  buffer_store_dwordx4 v[160:163], v2, s[56:59], s72 offen sc1
  s_add_u32 s72, s72, 4096
  s_waitcnt lgkmcnt(14)
  v_mfma_f32_16x16x32_bf16 v[216:219], v[20:23], v[104:107], v[216:219]
  v_mfma_f32_16x16x32_bf16 v[220:223], v[20:23], v[108:111], v[220:223]
  ds_read_b64_tr_b16 v[20:21], v6 offset:20480
  ds_read_b64_tr_b16 v[22:23], v6 offset:20992
  s_waitcnt lgkmcnt(14)
  v_mfma_f32_16x16x32_bf16 v[224:227], v[24:27], v[104:107], v[224:227]
  v_mfma_f32_16x16x32_bf16 v[228:231], v[24:27], v[108:111], v[228:231]
  ds_read_b64_tr_b16 v[24:25], v5 offset:16640
  ds_read_b64_tr_b16 v[26:27], v5 offset:17152
  s_waitcnt lgkmcnt(14)
  v_mfma_f32_16x16x32_bf16 v[232:235], v[28:31], v[104:107], v[232:235]
  v_mfma_f32_16x16x32_bf16 v[236:239], v[28:31], v[108:111], v[236:239]
  ds_read_b64_tr_b16 v[28:29], v5 offset:20736
  ds_read_b64_tr_b16 v[30:31], v5 offset:21248
  s_waitcnt lgkmcnt(14)
  v_mfma_f32_16x16x32_bf16 v[240:243], v[32:35], v[104:107], v[240:243]
  v_mfma_f32_16x16x32_bf16 v[244:247], v[32:35], v[108:111], v[244:247]
  s_barrier
  ds_read_b64_tr_b16 v[32:33], v3 offset:32768
  ds_read_b64_tr_b16 v[34:35], v3 offset:33792
  s_waitcnt lgkmcnt(14)
  v_mfma_f32_16x16x32_bf16 v[248:251], v[36:39], v[104:107], v[248:251]
  v_mfma_f32_16x16x32_bf16 v[252:255], v[36:39], v[108:111], v[252:255]
  ds_read_b64_tr_b16 v[36:37], v4 offset:32768
  ds_read_b64_tr_b16 v[38:39], v4 offset:33792
  s_waitcnt lgkmcnt(14)
  v_mfma_f32_16x16x32_bf16 v[40:43], v[88:91], v[104:107], v[40:43]
  v_mfma_f32_16x16x32_bf16 v[44:47], v[88:91], v[108:111], v[44:47]
  ds_read_b64_tr_b16 v[88:89], v3 offset:33024
  ds_read_b64_tr_b16 v[90:91], v3 offset:34048
  s_waitcnt lgkmcnt(14)
  v_mfma_f32_16x16x32_bf16 v[48:51], v[92:95], v[104:107], v[48:51]
  v_mfma_f32_16x16x32_bf16 v[52:55], v[92:95], v[108:111], v[52:55]
  ds_read_b64_tr_b16 v[92:93], v4 offset:33024
  ds_read_b64_tr_b16 v[94:95], v4 offset:34048
  s_mov_b32 m0, s16
  s_nop 0
  buffer_load_dwordx4 v9, s[12:15], s29 offen lds
  s_waitcnt lgkmcnt(14)
  v_mfma_f32_16x16x32_bf16 v[56:59], v[16:19], v[104:107], v[56:59]
  v_mfma_f32_16x16x32_bf16 v[60:63], v[16:19], v[108:111], v[60:63]
  ds_read_b64_tr_b16 v[16:17], v3 offset:33280
  ds_read_b64_tr_b16 v[18:19], v3 offset:34304
  s_add_u32 m0, s16, 8192
  s_add_u32 s29, s29, 262144
  buffer_load_dwordx4 v10, s[52:55], s43 offen lds
  s_add_u32 s43, s43, 88064
  s_add_u32 s16, s16, 16384
  s_and_b32 s16, s16, 0x1ffff
  s_waitcnt lgkmcnt(14)
  v_mfma_f32_16x16x32_bf16 v[64:67], v[20:23], v[104:107], v[64:67]
  v_mfma_f32_16x16x32_bf16 v[68:71], v[20:23], v[108:111], v[68:71]
  ds_read_b64_tr_b16 v[20:21], v4 offset:33280
  ds_read_b64_tr_b16 v[22:23], v4 offset:34304
  s_mov_b32 m0, s16
  s_nop 0
  buffer_load_dwordx4 v9, s[12:15], s29 offen lds
  s_waitcnt lgkmcnt(14)
  v_mfma_f32_16x16x32_bf16 v[72:75], v[24:27], v[104:107], v[72:75]
  v_mfma_f32_16x16x32_bf16 v[76:79], v[24:27], v[108:111], v[76:79]
  ds_read_b64_tr_b16 v[24:25], v3 offset:33536
  ds_read_b64_tr_b16 v[26:27], v3 offset:34560
  s_add_u32 m0, s16, 8192
  s_add_u32 s29, s29, 262144
  buffer_load_dwordx4 v10, s[52:55], s43 offen lds
  s_add_u32 s43, s43, 88064
  s_add_u32 s16, s16, 16384
  s_and_b32 s16, s16, 0x1ffff
  s_waitcnt lgkmcnt(14)
  v_mfma_f32_16x16x32_bf16 v[80:83], v[28:31], v[104:107], v[80:83]
  v_mfma_f32_16x16x32_bf16 v[84:87], v[28:31], v[108:111], v[84:87]
  ds_read_b64_tr_b16 v[28:29], v4 offset:33536
  ds_read_b64_tr_b16 v[30:31], v4 offset:34560
  s_add_u32 s65, s84, 9216
  buffer_load_dwordx4 v[104:107], v2, s[56:59], s65 offen sc1
  s_add_u32 s65, s84, 25600
  buffer_load_dwordx4 v[108:111], v2, s[56:59], s65 offen sc1
  s_waitcnt vmcnt(18)
  s_waitcnt lgkmcnt(14)
  v_mfma_f32_16x16x32_bf16 v[192:195], v[32:35], v[112:115], v[192:195]
  v_mfma_f32_16x16x32_bf16 v[196:199], v[32:35], v[116:119], v[196:199]
  ds_read_b64_tr_b16 v[32:33], v5 offset:32768
  ds_read_b64_tr_b16 v[34:35], v5 offset:33280
  s_waitcnt lgkmcnt(14)
  v_mfma_f32_16x16x32_bf16 v[200:203], v[36:39], v[112:115], v[200:203]
  v_mfma_f32_16x16x32_bf16 v[204:207], v[36:39], v[116:119], v[204:207]
  ds_read_b64_tr_b16 v[36:37], v5 offset:36864
  ds_read_b64_tr_b16 v[38:39], v5 offset:37376
  s_waitcnt lgkmcnt(14)
  v_mfma_f32_16x16x32_bf16 v[208:211], v[88:91], v[112:115], v[208:211]
  v_mfma_f32_16x16x32_bf16 v[212:215], v[88:91], v[116:119], v[212:215]
  ds_read_b64_tr_b16 v[88:89], v6 offset:32768
  ds_read_b64_tr_b16 v[90:91], v6 offset:33280
  buffer_store_dwordx4 v[164:167], v2, s[56:59], s72 offen sc1
  s_add_u32 s72, s72, 4096
  s_waitcnt lgkmcnt(14)
  v_mfma_f32_16x16x32_bf16 v[216:219], v[92:95], v[112:115], v[216:219]
  v_mfma_f32_16x16x32_bf16 v[220:223], v[92:95], v[116:119], v[220:223]
  ds_read_b64_tr_b16 v[92:93], v6 offset:36864
  ds_read_b64_tr_b16 v[94:95], v6 offset:37376
  s_waitcnt lgkmcnt(14)
  v_mfma_f32_16x16x32_bf16 v[224:227], v[16:19], v[112:115], v[224:227]
  v_mfma_f32_16x16x32_bf16 v[228:231], v[16:19], v[116:119], v[228:231]
  ds_read_b64_tr_b16 v[16:17], v5 offset:33024
  ds_read_b64_tr_b16 v[18:19], v5 offset:33536
  s_waitcnt lgkmcnt(14)
  v_mfma_f32_16x16x32_bf16 v[232:235], v[20:23], v[112:115], v[232:235]
  v_mfma_f32_16x16x32_bf16 v[236:239], v[20:23], v[116:119], v[236:239]
  ds_read_b64_tr_b16 v[20:21], v5 offset:37120
  ds_read_b64_tr_b16 v[22:23], v5 offset:37632
  s_waitcnt lgkmcnt(14)
  v_mfma_f32_16x16x32_bf16 v[240:243], v[24:27], v[112:115], v[240:243]
  v_mfma_f32_16x16x32_bf16 v[244:247], v[24:27], v[116:119], v[244:247]
  ds_read_b64_tr_b16 v[24:25], v3 offset:49152
  ds_read_b64_tr_b16 v[26:27], v3 offset:50176
  s_waitcnt lgkmcnt(14)
  v_mfma_f32_16x16x32_bf16 v[248:251], v[28:31], v[112:115], v[248:251]
  v_mfma_f32_16x16x32_bf16 v[252:255], v[28:31], v[116:119], v[252:255]
  ds_read_b64_tr_b16 v[28:29], v4 offset:49152
  ds_read_b64_tr_b16 v[30:31], v4 offset:50176
  buffer_store_dwordx4 v[168:171], v2, s[56:59], s73 offen sc1
  s_waitcnt lgkmcnt(14)
  v_mfma_f32_16x16x32_bf16 v[40:43], v[32:35], v[112:115], v[40:43]
  v_mfma_f32_16x16x32_bf16 v[44:47], v[32:35], v[116:119], v[44:47]
  ds_read_b64_tr_b16 v[32:33], v3 offset:49408
  ds_read_b64_tr_b16 v[34:35], v3 offset:50432
  s_waitcnt lgkmcnt(14)
  v_mfma_f32_16x16x32_bf16 v[48:51], v[36:39], v[112:115], v[48:51]
  v_mfma_f32_16x16x32_bf16 v[52:55], v[36:39], v[116:119], v[52:55]
  ds_read_b64_tr_b16 v[36:37], v4 offset:49408
  ds_read_b64_tr_b16 v[38:39], v4 offset:50432
  s_waitcnt lgkmcnt(14)
  v_mfma_f32_16x16x32_bf16 v[56:59], v[88:91], v[112:115], v[56:59]
  v_mfma_f32_16x16x32_bf16 v[60:63], v[88:91], v[116:119], v[60:63]
  ds_read_b64_tr_b16 v[88:89], v3 offset:49664
  ds_read_b64_tr_b16 v[90:91], v3 offset:50688
  s_waitcnt lgkmcnt(14)
  v_mfma_f32_16x16x32_bf16 v[64:67], v[92:95], v[112:115], v[64:67]
  v_mfma_f32_16x16x32_bf16 v[68:71], v[92:95], v[116:119], v[68:71]
  ds_read_b64_tr_b16 v[92:93], v4 offset:49664
  ds_read_b64_tr_b16 v[94:95], v4 offset:50688
  s_waitcnt lgkmcnt(14)
  v_mfma_f32_16x16x32_bf16 v[72:75], v[16:19], v[112:115], v[72:75]
  v_mfma_f32_16x16x32_bf16 v[76:79], v[16:19], v[116:119], v[76:79]
  ds_read_b64_tr_b16 v[16:17], v3 offset:49920
  ds_read_b64_tr_b16 v[18:19], v3 offset:50944
  s_waitcnt lgkmcnt(14)
  v_mfma_f32_16x16x32_bf16 v[80:83], v[20:23], v[112:115], v[80:83]
  v_mfma_f32_16x16x32_bf16 v[84:87], v[20:23], v[116:119], v[84:87]
  ds_read_b64_tr_b16 v[20:21], v4 offset:49920
  ds_read_b64_tr_b16 v[22:23], v4 offset:50944
  s_add_u32 s65, s84, 10240
  buffer_load_dwordx4 v[112:115], v2, s[56:59], s65 offen sc1
  s_add_u32 s65, s84, 26624
  buffer_load_dwordx4 v[116:119], v2, s[56:59], s65 offen sc1
  s_waitcnt vmcnt(15)
  s_waitcnt lgkmcnt(14)
  v_mfma_f32_16x16x32_bf16 v[192:195], v[24:27], v[120:123], v[192:195]
  v_mfma_f32_16x16x32_bf16 v[196:199], v[24:27], v[124:127], v[196:199]
  ds_read_b64_tr_b16 v[24:25], v5 offset:49152
  ds_read_b64_tr_b16 v[26:27], v5 offset:49664
  s_waitcnt lgkmcnt(14)
  v_mfma_f32_16x16x32_bf16 v[200:203], v[28:31], v[120:123], v[200:203]
  v_mfma_f32_16x16x32_bf16 v[204:207], v[28:31], v[124:127], v[204:207]
  ds_read_b64_tr_b16 v[28:29], v5 offset:53248
  ds_read_b64_tr_b16 v[30:31], v5 offset:53760
  s_waitcnt lgkmcnt(14)
  v_mfma_f32_16x16x32_bf16 v[208:211], v[32:35], v[120:123], v[208:211]
  v_mfma_f32_16x16x32_bf16 v[212:215], v[32:35], v[124:127], v[212:215]
  ds_read_b64_tr_b16 v[32:33], v6 offset:49152
  ds_read_b64_tr_b16 v[34:35], v6 offset:49664
  buffer_store_dwordx4 v[172:175], v2, s[56:59], s73 offen offset:1024 sc1
  s_add_u32 s73, s73, 8192
  s_waitcnt lgkmcnt(14)
  v_mfma_f32_16x16x32_bf16 v[216:219], v[36:39], v[120:123], v[216:219]
  v_mfma_f32_16x16x32_bf16 v[220:223], v[36:39], v[124:127], v[220:223]
  ds_read_b64_tr_b16 v[36:37], v6 offset:53248
  ds_read_b64_tr_b16 v[38:39], v6 offset:53760
  s_waitcnt lgkmcnt(14)
  v_mfma_f32_16x16x32_bf16 v[224:227], v[88:91], v[120:123], v[224:227]
  v_mfma_f32_16x16x32_bf16 v[228:231], v[88:91], v[124:127], v[228:231]
  ds_read_b64_tr_b16 v[88:89], v5 offset:49408
  ds_read_b64_tr_b16 v[90:91], v5 offset:49920
  s_waitcnt lgkmcnt(14)
  v_mfma_f32_16x16x32_bf16 v[232:235], v[92:95], v[120:123], v[232:235]
  v_mfma_f32_16x16x32_bf16 v[236:239], v[92:95], v[124:127], v[236:239]
  ds_read_b64_tr_b16 v[92:93], v5 offset:53504
  ds_read_b64_tr_b16 v[94:95], v5 offset:54016
  s_waitcnt lgkmcnt(14)
  v_mfma_f32_16x16x32_bf16 v[240:243], v[16:19], v[120:123], v[240:243]
  v_mfma_f32_16x16x32_bf16 v[244:247], v[16:19], v[124:127], v[244:247]
  s_barrier
  v_xor_b32 v3, 65536, v3
  v_xor_b32 v4, 65536, v4
  v_xor_b32 v5, 65536, v5
  v_xor_b32 v6, 65536, v6
  ds_read_b64_tr_b16 v[16:17], v3 offset:0
  ds_read_b64_tr_b16 v[18:19], v3 offset:1024
  s_waitcnt lgkmcnt(14)
  v_mfma_f32_16x16x32_bf16 v[248:251], v[20:23], v[120:123], v[248:251]
  v_mfma_f32_16x16x32_bf16 v[252:255], v[20:23], v[124:127], v[252:255]
  ds_read_b64_tr_b16 v[20:21], v4 offset:0
  ds_read_b64_tr_b16 v[22:23], v4 offset:1024
  s_waitcnt lgkmcnt(14)
  v_mfma_f32_16x16x32_bf16 v[40:43], v[24:27], v[120:123], v[40:43]
  v_mfma_f32_16x16x32_bf16 v[44:47], v[24:27], v[124:127], v[44:47]
  ds_read_b64_tr_b16 v[24:25], v3 offset:256
  ds_read_b64_tr_b16 v[26:27], v3 offset:1280
  s_waitcnt lgkmcnt(14)
  v_mfma_f32_16x16x32_bf16 v[48:51], v[28:31], v[120:123], v[48:51]
  v_mfma_f32_16x16x32_bf16 v[52:55], v[28:31], v[124:127], v[52:55]
  ds_read_b64_tr_b16 v[28:29], v4 offset:256
  ds_read_b64_tr_b16 v[30:31], v4 offset:1280
  s_mov_b32 m0, s16
  s_nop 0
  buffer_load_dwordx4 v9, s[12:15], s29 offen lds
  s_waitcnt lgkmcnt(14)
  v_mfma_f32_16x16x32_bf16 v[56:59], v[32:35], v[120:123], v[56:59]
  v_mfma_f32_16x16x32_bf16 v[60:63], v[32:35], v[124:127], v[60:63]
  ds_read_b64_tr_b16 v[32:33], v3 offset:512
  ds_read_b64_tr_b16 v[34:35], v3 offset:1536
  s_add_u32 m0, s16, 8192
  s_add_u32 s29, s29, 262144
  buffer_load_dwordx4 v10, s[52:55], s43 offen lds
  s_add_u32 s43, s43, 88064
  s_add_u32 s16, s16, 16384
  s_and_b32 s16, s16, 0x1ffff
  s_waitcnt lgkmcnt(14)
  v_mfma_f32_16x16x32_bf16 v[64:67], v[36:39], v[120:123], v[64:67]
  v_mfma_f32_16x16x32_bf16 v[68:71], v[36:39], v[124:127], v[68:71]
  ds_read_b64_tr_b16 v[36:37], v4 offset:512
  ds_read_b64_tr_b16 v[38:39], v4 offset:1536
  s_mov_b32 m0, s16
  s_nop 0
  buffer_load_dwordx4 v9, s[12:15], s29 offen lds
  s_waitcnt lgkmcnt(14)
  v_mfma_f32_16x16x32_bf16 v[72:75], v[88:91], v[120:123], v[72:75]
  v_mfma_f32_16x16x32_bf16 v[76:79], v[88:91], v[124:127], v[76:79]
  ds_read_b64_tr_b16 v[88:89], v3 offset:768
  ds_read_b64_tr_b16 v[90:91], v3 offset:1792
  s_add_u32 m0, s16, 8192
  s_add_u32 s29, s29, 262144
  buffer_load_dwordx4 v10, s[52:55], s43 offen lds
  s_add_u32 s43, s43, 88064
  s_add_u32 s16, s16, 16384
  s_and_b32 s16, s16, 0x1ffff
  s_waitcnt lgkmcnt(14)
  v_mfma_f32_16x16x32_bf16 v[80:83], v[92:95], v[120:123], v[80:83]
  v_mfma_f32_16x16x32_bf16 v[84:87], v[92:95], v[124:127], v[84:87]
  ds_read_b64_tr_b16 v[92:93], v4 offset:768
  ds_read_b64_tr_b16 v[94:95], v4 offset:1792
  s_add_u32 s65, s84, 11264
  buffer_load_dwordx4 v[120:123], v2, s[56:59], s65 offen sc1
  s_add_u32 s65, s84, 27648
  buffer_load_dwordx4 v[124:127], v2, s[56:59], s65 offen sc1
  s_waitcnt vmcnt(18)
  s_waitcnt lgkmcnt(14)
  v_mfma_f32_16x16x32_bf16 v[192:195], v[16:19], v[96:99], v[192:195]
  v_mfma_f32_16x16x32_bf16 v[196:199], v[16:19], v[100:103], v[196:199]
  ds_read_b64_tr_b16 v[16:17], v5 offset:0
  ds_read_b64_tr_b16 v[18:19], v5 offset:512
  s_waitcnt lgkmcnt(14)
  v_mfma_f32_16x16x32_bf16 v[200:203], v[20:23], v[96:99], v[200:203]
  v_mfma_f32_16x16x32_bf16 v[204:207], v[20:23], v[100:103], v[204:207]
  ds_read_b64_tr_b16 v[20:21], v5 offset:4096
  ds_read_b64_tr_b16 v[22:23], v5 offset:4608
  s_waitcnt lgkmcnt(14)
  v_mfma_f32_16x16x32_bf16 v[208:211], v[24:27], v[96:99], v[208:211]
  v_mfma_f32_16x16x32_bf16 v[212:215], v[24:27], v[100:103], v[212:215]
  ds_read_b64_tr_b16 v[24:25], v6 offset:0
  ds_read_b64_tr_b16 v[26:27], v6 offset:512
  buffer_store_dwordx4 v[176:179], v2, s[56:59], s72 offen sc1
  s_add_u32 s72, s72, 4096
  s_waitcnt lgkmcnt(14)
  v_mfma_f32_16x16x32_bf16 v[216:219], v[28:31], v[96:99], v[216:219]
  v_mfma_f32_16x16x32_bf16 v[220:223], v[28:31], v[100:103], v[220:223]
  ds_read_b64_tr_b16 v[28:29], v6 offset:4096
  ds_read_b64_tr_b16 v[30:31], v6 offset:4608
  s_waitcnt lgkmcnt(14)
  v_mfma_f32_16x16x32_bf16 v[224:227], v[32:35], v[96:99], v[224:227]
  v_mfma_f32_16x16x32_bf16 v[228:231], v[32:35], v[100:103], v[228:231]
  ds_read_b64_tr_b16 v[32:33], v5 offset:256
  ds_read_b64_tr_b16 v[34:35], v5 offset:768
  s_waitcnt lgkmcnt(14)
  v_mfma_f32_16x16x32_bf16 v[232:235], v[36:39], v[96:99], v[232:235]
  v_mfma_f32_16x16x32_bf16 v[236:239], v[36:39], v[100:103], v[236:239]
  ds_read_b64_tr_b16 v[36:37], v5 offset:4352
  ds_read_b64_tr_b16 v[38:39], v5 offset:4864
  s_waitcnt lgkmcnt(14)
  v_mfma_f32_16x16x32_bf16 v[240:243], v[88:91], v[96:99], v[240:243]
  v_mfma_f32_16x16x32_bf16 v[244:247], v[88:91], v[100:103], v[244:247]
  ds_read_b64_tr_b16 v[88:89], v3 offset:16384
  ds_read_b64_tr_b16 v[90:91], v3 offset:17408
  s_waitcnt lgkmcnt(14)
  v_mfma_f32_16x16x32_bf16 v[248:251], v[92:95], v[96:99], v[248:251]
  v_mfma_f32_16x16x32_bf16 v[252:255], v[92:95], v[100:103], v[252:255]
  ds_read_b64_tr_b16 v[92:93], v4 offset:16384
  ds_read_b64_tr_b16 v[94:95], v4 offset:17408
  buffer_store_dwordx4 v[180:183], v2, s[56:59], s72 offen sc1
  s_add_u32 s72, s72, 4096
  s_waitcnt lgkmcnt(14)
  v_mfma_f32_16x16x32_bf16 v[40:43], v[16:19], v[96:99], v[40:43]
  v_mfma_f32_16x16x32_bf16 v[44:47], v[16:19], v[100:103], v[44:47]
  ds_read_b64_tr_b16 v[16:17], v3 offset:16640
  ds_read_b64_tr_b16 v[18:19], v3 offset:17664
  s_waitcnt lgkmcnt(14)
  v_mfma_f32_16x16x32_bf16 v[48:51], v[20:23], v[96:99], v[48:51]
  v_mfma_f32_16x16x32_bf16 v[52:55], v[20:23], v[100:103], v[52:55]
  ds_read_b64_tr_b16 v[20:21], v4 offset:16640
  ds_read_b64_tr_b16 v[22:23], v4 offset:17664
  s_waitcnt lgkmcnt(14)
  v_mfma_f32_16x16x32_bf16 v[56:59], v[24:27], v[96:99], v[56:59]
  v_mfma_f32_16x16x32_bf16 v[60:63], v[24:27], v[100:103], v[60:63]
  ds_read_b64_tr_b16 v[24:25], v3 offset:16896
  ds_read_b64_tr_b16 v[26:27], v3 offset:17920
  s_waitcnt lgkmcnt(14)
  v_mfma_f32_16x16x32_bf16 v[64:67], v[28:31], v[96:99], v[64:67]
  v_mfma_f32_16x16x32_bf16 v[68:71], v[28:31], v[100:103], v[68:71]
  ds_read_b64_tr_b16 v[28:29], v4 offset:16896
  ds_read_b64_tr_b16 v[30:31], v4 offset:17920
  s_waitcnt lgkmcnt(14)
  v_mfma_f32_16x16x32_bf16 v[72:75], v[32:35], v[96:99], v[72:75]
  v_mfma_f32_16x16x32_bf16 v[76:79], v[32:35], v[100:103], v[76:79]
  ds_read_b64_tr_b16 v[32:33], v3 offset:17152
  ds_read_b64_tr_b16 v[34:35], v3 offset:18176
  s_waitcnt lgkmcnt(14)
  v_mfma_f32_16x16x32_bf16 v[80:83], v[36:39], v[96:99], v[80:83]
  v_mfma_f32_16x16x32_bf16 v[84:87], v[36:39], v[100:103], v[84:87]
  ds_read_b64_tr_b16 v[36:37], v4 offset:17152
  ds_read_b64_tr_b16 v[38:39], v4 offset:18176
  s_add_u32 s65, s84, 12288
  buffer_load_dwordx4 v[96:99], v2, s[56:59], s65 offen sc1
  s_add_u32 s65, s84, 28672
  buffer_load_dwordx4 v[100:103], v2, s[56:59], s65 offen sc1
  s_waitcnt vmcnt(15)
  s_waitcnt lgkmcnt(14)
  v_mfma_f32_16x16x32_bf16 v[192:195], v[88:91], v[104:107], v[192:195]
  v_mfma_f32_16x16x32_bf16 v[196:199], v[88:91], v[108:111], v[196:199]
  ds_read_b64_tr_b16 v[88:89], v5 offset:16384
  ds_read_b64_tr_b16 v[90:91], v5 offset:16896
  s_waitcnt lgkmcnt(14)
  v_mfma_f32_16x16x32_bf16 v[200:203], v[92:95], v[104:107], v[200:203]
  v_mfma_f32_16x16x32_bf16 v[204:207], v[92:95], v[108:111], v[204:207]
  ds_read_b64_tr_b16 v[92:93], v5 offset:20480
  ds_read_b64_tr_b16 v[94:95], v5 offset:20992
  s_waitcnt lgkmcnt(14)
  v_mfma_f32_16x16x32_bf16 v[208:211], v[16:19], v[104:107], v[208:211]
  v_mfma_f32_16x16x32_bf16 v[212:215], v[16:19], v[108:111], v[212:215]
  ds_read_b64_tr_b16 v[16:17], v6 offset:16384
  ds_read_b64_tr_b16 v[18:19], v6 offset:16896
  buffer_store_dwordx4 v[184:187], v2, s[56:59], s73 offen sc1
  s_waitcnt lgkmcnt(14)
  v_mfma_f32_16x16x32_bf16 v[216:219], v[20:23], v[104:107], v[216:219]
  v_mfma_f32_16x16x32_bf16 v[220:223], v[20:23], v[108:111], v[220:223]
  ds_read_b64_tr_b16 v[20:21], v6 offset:20480
  ds_read_b64_tr_b16 v[22:23], v6 offset:20992
  s_waitcnt lgkmcnt(14)
  v_mfma_f32_16x16x32_bf16 v[224:227], v[24:27], v[104:107], v[224:227]
  v_mfma_f32_16x16x32_bf16 v[228:231], v[24:27], v[108:111], v[228:231]
  ds_read_b64_tr_b16 v[24:25], v5 offset:16640
  ds_read_b64_tr_b16 v[26:27], v5 offset:17152
  s_waitcnt lgkmcnt(14)
  v_mfma_f32_16x16x32_bf16 v[232:235], v[28:31], v[104:107], v[232:235]
  v_mfma_f32_16x16x32_bf16 v[236:239], v[28:31], v[108:111], v[236:239]
  ds_read_b64_tr_b16 v[28:29], v5 offset:20736
  ds_read_b64_tr_b16 v[30:31], v5 offset:21248
  s_waitcnt lgkmcnt(14)
  v_mfma_f32_16x16x32_bf16 v[240:243], v[32:35], v[104:107], v[240:243]
  v_mfma_f32_16x16x32_bf16 v[244:247], v[32:35], v[108:111], v[244:247]
  s_barrier
  ds_read_b64_tr_b16 v[32:33], v3 offset:32768
  ds_read_b64_tr_b16 v[34:35], v3 offset:33792
  s_waitcnt lgkmcnt(14)
  v_mfma_f32_16x16x32_bf16 v[248:251], v[36:39], v[104:107], v[248:251]
  v_mfma_f32_16x16x32_bf16 v[252:255], v[36:39], v[108:111], v[252:255]
  ds_read_b64_tr_b16 v[36:37], v4 offset:32768
  ds_read_b64_tr_b16 v[38:39], v4 offset:33792
  s_waitcnt lgkmcnt(14)
  v_mfma_f32_16x16x32_bf16 v[40:43], v[88:91], v[104:107], v[40:43]
  v_mfma_f32_16x16x32_bf16 v[44:47], v[88:91], v[108:111], v[44:47]
  ds_read_b64_tr_b16 v[88:89], v3 offset:33024
  ds_read_b64_tr_b16 v[90:91], v3 offset:34048
  s_waitcnt lgkmcnt(14)
  v_mfma_f32_16x16x32_bf16 v[48:51], v[92:95], v[104:107], v[48:51]
  v_mfma_f32_16x16x32_bf16 v[52:55], v[92:95], v[108:111], v[52:55]
  ds_read_b64_tr_b16 v[92:93], v4 offset:33024
  ds_read_b64_tr_b16 v[94:95], v4 offset:34048
  s_mov_b32 m0, s16
  s_nop 0
  buffer_load_dwordx4 v9, s[12:15], s29 offen lds
  s_waitcnt lgkmcnt(14)
  v_mfma_f32_16x16x32_bf16 v[56:59], v[16:19], v[104:107], v[56:59]
  v_mfma_f32_16x16x32_bf16 v[60:63], v[16:19], v[108:111], v[60:63]
  ds_read_b64_tr_b16 v[16:17], v3 offset:33280
  ds_read_b64_tr_b16 v[18:19], v3 offset:34304
  s_add_u32 m0, s16, 8192
  s_add_u32 s29, s29, 262144
  buffer_load_dwordx4 v10, s[52:55], s43 offen lds
  s_add_u32 s43, s43, 88064
  s_add_u32 s16, s16, 16384
  s_and_b32 s16, s16, 0x1ffff
  s_waitcnt lgkmcnt(14)
  v_mfma_f32_16x16x32_bf16 v[64:67], v[20:23], v[104:107], v[64:67]
  v_mfma_f32_16x16x32_bf16 v[68:71], v[20:23], v[108:111], v[68:71]
  ds_read_b64_tr_b16 v[20:21], v4 offset:33280
  ds_read_b64_tr_b16 v[22:23], v4 offset:34304
  s_mov_b32 m0, s16
  s_nop 0
  buffer_load_dwordx4 v9, s[12:15], s29 offen lds
  s_waitcnt lgkmcnt(14)
  v_mfma_f32_16x16x32_bf16 v[72:75], v[24:27], v[104:107], v[72:75]
  v_mfma_f32_16x16x32_bf16 v[76:79], v[24:27], v[108:111], v[76:79]
  ds_read_b64_tr_b16 v[24:25], v3 offset:33536
  ds_read_b64_tr_b16 v[26:27], v3 offset:34560
  s_add_u32 m0, s16, 8192
  s_add_u32 s29, s29, 262144
  buffer_load_dwordx4 v10, s[52:55], s43 offen lds
  s_add_u32 s43, s43, 88064
  s_add_u32 s16, s16, 16384
  s_and_b32 s16, s16, 0x1ffff
  s_waitcnt lgkmcnt(14)
  v_mfma_f32_16x16x32_bf16 v[80:83], v[28:31], v[104:107], v[80:83]
  v_mfma_f32_16x16x32_bf16 v[84:87], v[28:31], v[108:111], v[84:87]
  ds_read_b64_tr_b16 v[28:29], v4 offset:33536
  ds_read_b64_tr_b16 v[30:31], v4 offset:34560
  s_add_u32 s65, s84, 13312
  buffer_load_dwordx4 v[104:107], v2, s[56:59], s65 offen sc1
  s_add_u32 s65, s84, 29696
  buffer_load_dwordx4 v[108:111], v2, s[56:59], s65 offen sc1
  s_waitcnt vmcnt(18)
  s_waitcnt lgkmcnt(14)
  v_mfma_f32_16x16x32_bf16 v[192:195], v[32:35], v[112:115], v[192:195]
  v_mfma_f32_16x16x32_bf16 v[196:199], v[32:35], v[116:119], v[196:199]
  ds_read_b64_tr_b16 v[32:33], v5 offset:32768
  ds_read_b64_tr_b16 v[34:35], v5 offset:33280
  s_waitcnt lgkmcnt(14)
  v_mfma_f32_16x16x32_bf16 v[200:203], v[36:39], v[112:115], v[200:203]
  v_mfma_f32_16x16x32_bf16 v[204:207], v[36:39], v[116:119], v[204:207]
  ds_read_b64_tr_b16 v[36:37], v5 offset:36864
  ds_read_b64_tr_b16 v[38:39], v5 offset:37376
  s_waitcnt lgkmcnt(14)
  v_mfma_f32_16x16x32_bf16 v[208:211], v[88:91], v[112:115], v[208:211]
  v_mfma_f32_16x16x32_bf16 v[212:215], v[88:91], v[116:119], v[212:215]
  ds_read_b64_tr_b16 v[88:89], v6 offset:32768
  ds_read_b64_tr_b16 v[90:91], v6 offset:33280
  buffer_store_dwordx4 v[188:191], v2, s[56:59], s73 offen offset:1024 sc1
  s_add_u32 s73, s73, 8192
  s_waitcnt lgkmcnt(14)
  v_mfma_f32_16x16x32_bf16 v[216:219], v[92:95], v[112:115], v[216:219]
  v_mfma_f32_16x16x32_bf16 v[220:223], v[92:95], v[116:119], v[220:223]
  ds_read_b64_tr_b16 v[92:93], v6 offset:36864
  ds_read_b64_tr_b16 v[94:95], v6 offset:37376
  s_waitcnt lgkmcnt(14)
  v_mfma_f32_16x16x32_bf16 v[224:227], v[16:19], v[112:115], v[224:227]
  v_mfma_f32_16x16x32_bf16 v[228:231], v[16:19], v[116:119], v[228:231]
  ds_read_b64_tr_b16 v[16:17], v5 offset:33024
  ds_read_b64_tr_b16 v[18:19], v5 offset:33536
  s_waitcnt lgkmcnt(14)
  v_mfma_f32_16x16x32_bf16 v[232:235], v[20:23], v[112:115], v[232:235]
  v_mfma_f32_16x16x32_bf16 v[236:239], v[20:23], v[116:119], v[236:239]
  ds_read_b64_tr_b16 v[20:21], v5 offset:37120
  ds_read_b64_tr_b16 v[22:23], v5 offset:37632
  s_waitcnt lgkmcnt(14)
  v_mfma_f32_16x16x32_bf16 v[240:243], v[24:27], v[112:115], v[240:243]
  v_mfma_f32_16x16x32_bf16 v[244:247], v[24:27], v[116:119], v[244:247]
  ds_read_b64_tr_b16 v[24:25], v3 offset:49152
  ds_read_b64_tr_b16 v[26:27], v3 offset:50176
  s_waitcnt lgkmcnt(14)
  v_mfma_f32_16x16x32_bf16 v[248:251], v[28:31], v[112:115], v[248:251]
  v_mfma_f32_16x16x32_bf16 v[252:255], v[28:31], v[116:119], v[252:255]
  ds_read_b64_tr_b16 v[28:29], v4 offset:49152
  ds_read_b64_tr_b16 v[30:31], v4 offset:50176
  s_waitcnt lgkmcnt(14)
  v_mfma_f32_16x16x32_bf16 v[40:43], v[32:35], v[112:115], v[40:43]
  v_mfma_f32_16x16x32_bf16 v[44:47], v[32:35], v[116:119], v[44:47]
  ds_read_b64_tr_b16 v[32:33], v3 offset:49408
  ds_read_b64_tr_b16 v[34:35], v3 offset:50432
  s_waitcnt lgkmcnt(14)
  v_mfma_f32_16x16x32_bf16 v[48:51], v[36:39], v[112:115], v[48:51]
  v_mfma_f32_16x16x32_bf16 v[52:55], v[36:39], v[116:119], v[52:55]
  ds_read_b64_tr_b16 v[36:37], v4 offset:49408
  ds_read_b64_tr_b16 v[38:39], v4 offset:50432
  s_waitcnt lgkmcnt(14)
  v_mfma_f32_16x16x32_bf16 v[56:59], v[88:91], v[112:115], v[56:59]
  v_mfma_f32_16x16x32_bf16 v[60:63], v[88:91], v[116:119], v[60:63]
  ds_read_b64_tr_b16 v[88:89], v3 offset:49664
  ds_read_b64_tr_b16 v[90:91], v3 offset:50688
  s_waitcnt lgkmcnt(14)
  v_mfma_f32_16x16x32_bf16 v[64:67], v[92:95], v[112:115], v[64:67]
  v_mfma_f32_16x16x32_bf16 v[68:71], v[92:95], v[116:119], v[68:71]
  ds_read_b64_tr_b16 v[92:93], v4 offset:49664
  ds_read_b64_tr_b16 v[94:95], v4 offset:50688
  s_waitcnt lgkmcnt(14)
  v_mfma_f32_16x16x32_bf16 v[72:75], v[16:19], v[112:115], v[72:75]
  v_mfma_f32_16x16x32_bf16 v[76:79], v[16:19], v[116:119], v[76:79]
  ds_read_b64_tr_b16 v[16:17], v3 offset:49920
  ds_read_b64_tr_b16 v[18:19], v3 offset:50944
  s_waitcnt lgkmcnt(14)
  v_mfma_f32_16x16x32_bf16 v[80:83], v[20:23], v[112:115], v[80:83]
  v_mfma_f32_16x16x32_bf16 v[84:87], v[20:23], v[116:119], v[84:87]
  ds_read_b64_tr_b16 v[20:21], v4 offset:49920
  ds_read_b64_tr_b16 v[22:23], v4 offset:50944
  s_add_u32 s65, s84, 14336
  buffer_load_dwordx4 v[112:115], v2, s[56:59], s65 offen sc1
  s_add_u32 s65, s84, 30720
  buffer_load_dwordx4 v[116:119], v2, s[56:59], s65 offen sc1
  s_waitcnt vmcnt(14)
  s_waitcnt lgkmcnt(14)
  v_mfma_f32_16x16x32_bf16 v[192:195], v[24:27], v[120:123], v[192:195]
  v_mfma_f32_16x16x32_bf16 v[196:199], v[24:27], v[124:127], v[196:199]
  ds_read_b64_tr_b16 v[24:25], v5 offset:49152
  ds_read_b64_tr_b16 v[26:27], v5 offset:49664
  s_waitcnt lgkmcnt(14)
  v_mfma_f32_16x16x32_bf16 v[200:203], v[28:31], v[120:123], v[200:203]
  v_mfma_f32_16x16x32_bf16 v[204:207], v[28:31], v[124:127], v[204:207]
  ds_read_b64_tr_b16 v[28:29], v5 offset:53248
  ds_read_b64_tr_b16 v[30:31], v5 offset:53760
  s_waitcnt lgkmcnt(14)
  v_mfma_f32_16x16x32_bf16 v[208:211], v[32:35], v[120:123], v[208:211]
  v_mfma_f32_16x16x32_bf16 v[212:215], v[32:35], v[124:127], v[212:215]
  ds_read_b64_tr_b16 v[32:33], v6 offset:49152
  ds_read_b64_tr_b16 v[34:35], v6 offset:49664
  s_waitcnt lgkmcnt(14)
  v_mfma_f32_16x16x32_bf16 v[216:219], v[36:39], v[120:123], v[216:219]
  v_mfma_f32_16x16x32_bf16 v[220:223], v[36:39], v[124:127], v[220:223]
  ds_read_b64_tr_b16 v[36:37], v6 offset:53248
  ds_read_b64_tr_b16 v[38:39], v6 offset:53760
  s_waitcnt lgkmcnt(14)
  v_mfma_f32_16x16x32_bf16 v[224:227], v[88:91], v[120:123], v[224:227]
  v_mfma_f32_16x16x32_bf16 v[228:231], v[88:91], v[124:127], v[228:231]
  ds_read_b64_tr_b16 v[88:89], v5 offset:49408
  ds_read_b64_tr_b16 v[90:91], v5 offset:49920
  s_waitcnt lgkmcnt(14)
  v_mfma_f32_16x16x32_bf16 v[232:235], v[92:95], v[120:123], v[232:235]
  v_mfma_f32_16x16x32_bf16 v[236:239], v[92:95], v[124:127], v[236:239]
  ds_read_b64_tr_b16 v[92:93], v5 offset:53504
  ds_read_b64_tr_b16 v[94:95], v5 offset:54016
  s_waitcnt lgkmcnt(14)
  v_mfma_f32_16x16x32_bf16 v[240:243], v[16:19], v[120:123], v[240:243]
  v_mfma_f32_16x16x32_bf16 v[244:247], v[16:19], v[124:127], v[244:247]
  s_barrier
  v_xor_b32 v3, 65536, v3
  v_xor_b32 v4, 65536, v4
  v_xor_b32 v5, 65536, v5
  v_xor_b32 v6, 65536, v6
  ds_read_b64_tr_b16 v[16:17], v3 offset:0
  ds_read_b64_tr_b16 v[18:19], v3 offset:1024
  s_waitcnt lgkmcnt(14)
  v_mfma_f32_16x16x32_bf16 v[248:251], v[20:23], v[120:123], v[248:251]
  v_mfma_f32_16x16x32_bf16 v[252:255], v[20:23], v[124:127], v[252:255]
  ds_read_b64_tr_b16 v[20:21], v4 offset:0
  ds_read_b64_tr_b16 v[22:23], v4 offset:1024
  s_waitcnt lgkmcnt(14)
  v_mfma_f32_16x16x32_bf16 v[40:43], v[24:27], v[120:123], v[40:43]
  v_mfma_f32_16x16x32_bf16 v[44:47], v[24:27], v[124:127], v[44:47]
  ds_read_b64_tr_b16 v[24:25], v3 offset:256
  ds_read_b64_tr_b16 v[26:27], v3 offset:1280
  s_waitcnt lgkmcnt(14)
  v_mfma_f32_16x16x32_bf16 v[48:51], v[28:31], v[120:123], v[48:51]
  v_mfma_f32_16x16x32_bf16 v[52:55], v[28:31], v[124:127], v[52:55]
  ds_read_b64_tr_b16 v[28:29], v4 offset:256
  ds_read_b64_tr_b16 v[30:31], v4 offset:1280
  s_waitcnt lgkmcnt(14)
  v_mfma_f32_16x16x32_bf16 v[56:59], v[32:35], v[120:123], v[56:59]
  v_mfma_f32_16x16x32_bf16 v[60:63], v[32:35], v[124:127], v[60:63]
  ds_read_b64_tr_b16 v[32:33], v3 offset:512
  ds_read_b64_tr_b16 v[34:35], v3 offset:1536
  s_waitcnt lgkmcnt(14)
  v_mfma_f32_16x16x32_bf16 v[64:67], v[36:39], v[120:123], v[64:67]
  v_mfma_f32_16x16x32_bf16 v[68:71], v[36:39], v[124:127], v[68:71]
  ds_read_b64_tr_b16 v[36:37], v4 offset:512
  ds_read_b64_tr_b16 v[38:39], v4 offset:1536
  s_waitcnt lgkmcnt(14)
  v_mfma_f32_16x16x32_bf16 v[72:75], v[88:91], v[120:123], v[72:75]
  v_mfma_f32_16x16x32_bf16 v[76:79], v[88:91], v[124:127], v[76:79]
  ds_read_b64_tr_b16 v[88:89], v3 offset:768
  ds_read_b64_tr_b16 v[90:91], v3 offset:1792
  s_waitcnt lgkmcnt(14)
  v_mfma_f32_16x16x32_bf16 v[80:83], v[92:95], v[120:123], v[80:83]
  v_mfma_f32_16x16x32_bf16 v[84:87], v[92:95], v[124:127], v[84:87]
  ds_read_b64_tr_b16 v[92:93], v4 offset:768
  ds_read_b64_tr_b16 v[94:95], v4 offset:1792
  s_add_u32 s65, s84, 15360
  buffer_load_dwordx4 v[120:123], v2, s[56:59], s65 offen sc1
  s_add_u32 s65, s84, 31744
  buffer_load_dwordx4 v[124:127], v2, s[56:59], s65 offen sc1
  s_waitcnt vmcnt(12)
  s_waitcnt lgkmcnt(14)
  v_mfma_f32_16x16x32_bf16 v[192:195], v[16:19], v[96:99], v[192:195]
  v_mfma_f32_16x16x32_bf16 v[196:199], v[16:19], v[100:103], v[196:199]
  ds_read_b64_tr_b16 v[16:17], v5 offset:0
  ds_read_b64_tr_b16 v[18:19], v5 offset:512
  s_waitcnt lgkmcnt(14)
  v_mfma_f32_16x16x32_bf16 v[200:203], v[20:23], v[96:99], v[200:203]
  v_mfma_f32_16x16x32_bf16 v[204:207], v[20:23], v[100:103], v[204:207]
  ds_read_b64_tr_b16 v[20:21], v5 offset:4096
  ds_read_b64_tr_b16 v[22:23], v5 offset:4608
  s_waitcnt lgkmcnt(14)
  v_mfma_f32_16x16x32_bf16 v[208:211], v[24:27], v[96:99], v[208:211]
  v_mfma_f32_16x16x32_bf16 v[212:215], v[24:27], v[100:103], v[212:215]
  ds_read_b64_tr_b16 v[24:25], v6 offset:0
  ds_read_b64_tr_b16 v[26:27], v6 offset:512
  s_waitcnt lgkmcnt(14)
  v_mfma_f32_16x16x32_bf16 v[216:219], v[28:31], v[96:99], v[216:219]
  v_mfma_f32_16x16x32_bf16 v[220:223], v[28:31], v[100:103], v[220:223]
  ds_read_b64_tr_b16 v[28:29], v6 offset:4096
  ds_read_b64_tr_b16 v[30:31], v6 offset:4608
  s_waitcnt lgkmcnt(14)
  v_mfma_f32_16x16x32_bf16 v[224:227], v[32:35], v[96:99], v[224:227]
  v_mfma_f32_16x16x32_bf16 v[228:231], v[32:35], v[100:103], v[228:231]
  ds_read_b64_tr_b16 v[32:33], v5 offset:256
  ds_read_b64_tr_b16 v[34:35], v5 offset:768
  s_waitcnt lgkmcnt(14)
  v_mfma_f32_16x16x32_bf16 v[232:235], v[36:39], v[96:99], v[232:235]
  v_mfma_f32_16x16x32_bf16 v[236:239], v[36:39], v[100:103], v[236:239]
  ds_read_b64_tr_b16 v[36:37], v5 offset:4352
  ds_read_b64_tr_b16 v[38:39], v5 offset:4864
  s_waitcnt lgkmcnt(14)
  v_mfma_f32_16x16x32_bf16 v[240:243], v[88:91], v[96:99], v[240:243]
  v_mfma_f32_16x16x32_bf16 v[244:247], v[88:91], v[100:103], v[244:247]
  ds_read_b64_tr_b16 v[88:89], v3 offset:16384
  ds_read_b64_tr_b16 v[90:91], v3 offset:17408
  s_waitcnt lgkmcnt(14)
  v_mfma_f32_16x16x32_bf16 v[248:251], v[92:95], v[96:99], v[248:251]
  v_mfma_f32_16x16x32_bf16 v[252:255], v[92:95], v[100:103], v[252:255]
  ds_read_b64_tr_b16 v[92:93], v4 offset:16384
  ds_read_b64_tr_b16 v[94:95], v4 offset:17408
  s_waitcnt lgkmcnt(14)
  v_mfma_f32_16x16x32_bf16 v[40:43], v[16:19], v[96:99], v[40:43]
  v_mfma_f32_16x16x32_bf16 v[44:47], v[16:19], v[100:103], v[44:47]
  ds_read_b64_tr_b16 v[16:17], v3 offset:16640
  ds_read_b64_tr_b16 v[18:19], v3 offset:17664
  s_waitcnt lgkmcnt(14)
  v_mfma_f32_16x16x32_bf16 v[48:51], v[20:23], v[96:99], v[48:51]
  v_mfma_f32_16x16x32_bf16 v[52:55], v[20:23], v[100:103], v[52:55]
  ds_read_b64_tr_b16 v[20:21], v4 offset:16640
  ds_read_b64_tr_b16 v[22:23], v4 offset:17664
  s_waitcnt lgkmcnt(14)
  v_mfma_f32_16x16x32_bf16 v[56:59], v[24:27], v[96:99], v[56:59]
  v_mfma_f32_16x16x32_bf16 v[60:63], v[24:27], v[100:103], v[60:63]
  ds_read_b64_tr_b16 v[24:25], v3 offset:16896
  ds_read_b64_tr_b16 v[26:27], v3 offset:17920
  s_waitcnt lgkmcnt(14)
  v_mfma_f32_16x16x32_bf16 v[64:67], v[28:31], v[96:99], v[64:67]
  v_mfma_f32_16x16x32_bf16 v[68:71], v[28:31], v[100:103], v[68:71]
  ds_read_b64_tr_b16 v[28:29], v4 offset:16896
  ds_read_b64_tr_b16 v[30:31], v4 offset:17920
  s_waitcnt lgkmcnt(14)
  v_mfma_f32_16x16x32_bf16 v[72:75], v[32:35], v[96:99], v[72:75]
  v_mfma_f32_16x16x32_bf16 v[76:79], v[32:35], v[100:103], v[76:79]
  ds_read_b64_tr_b16 v[32:33], v3 offset:17152
  ds_read_b64_tr_b16 v[34:35], v3 offset:18176
  s_waitcnt lgkmcnt(14)
  v_mfma_f32_16x16x32_bf16 v[80:83], v[36:39], v[96:99], v[80:83]
  v_mfma_f32_16x16x32_bf16 v[84:87], v[36:39], v[100:103], v[84:87]
  ds_read_b64_tr_b16 v[36:37], v4 offset:17152
  ds_read_b64_tr_b16 v[38:39], v4 offset:18176
  s_waitcnt vmcnt(5)
  s_waitcnt lgkmcnt(14)
  v_mfma_f32_16x16x32_bf16 v[192:195], v[88:91], v[104:107], v[192:195]
  v_mfma_f32_16x16x32_bf16 v[196:199], v[88:91], v[108:111], v[196:199]
  ds_read_b64_tr_b16 v[88:89], v5 offset:16384
  ds_read_b64_tr_b16 v[90:91], v5 offset:16896
  s_waitcnt lgkmcnt(14)
  v_mfma_f32_16x16x32_bf16 v[200:203], v[92:95], v[104:107], v[200:203]
  v_mfma_f32_16x16x32_bf16 v[204:207], v[92:95], v[108:111], v[204:207]
  ds_read_b64_tr_b16 v[92:93], v5 offset:20480
  ds_read_b64_tr_b16 v[94:95], v5 offset:20992
  s_waitcnt lgkmcnt(14)
  v_mfma_f32_16x16x32_bf16 v[208:211], v[16:19], v[104:107], v[208:211]
  v_mfma_f32_16x16x32_bf16 v[212:215], v[16:19], v[108:111], v[212:215]
  ds_read_b64_tr_b16 v[16:17], v6 offset:16384
  ds_read_b64_tr_b16 v[18:19], v6 offset:16896
  s_waitcnt lgkmcnt(14)
  v_mfma_f32_16x16x32_bf16 v[216:219], v[20:23], v[104:107], v[216:219]
  v_mfma_f32_16x16x32_bf16 v[220:223], v[20:23], v[108:111], v[220:223]
  ds_read_b64_tr_b16 v[20:21], v6 offset:20480
  ds_read_b64_tr_b16 v[22:23], v6 offset:20992
  s_waitcnt lgkmcnt(14)
  v_mfma_f32_16x16x32_bf16 v[224:227], v[24:27], v[104:107], v[224:227]
  v_mfma_f32_16x16x32_bf16 v[228:231], v[24:27], v[108:111], v[228:231]
  ds_read_b64_tr_b16 v[24:25], v5 offset:16640
  ds_read_b64_tr_b16 v[26:27], v5 offset:17152
  s_waitcnt lgkmcnt(14)
  v_mfma_f32_16x16x32_bf16 v[232:235], v[28:31], v[104:107], v[232:235]
  v_mfma_f32_16x16x32_bf16 v[236:239], v[28:31], v[108:111], v[236:239]
  ds_read_b64_tr_b16 v[28:29], v5 offset:20736
  ds_read_b64_tr_b16 v[30:31], v5 offset:21248
  s_waitcnt vmcnt(4)
  s_waitcnt lgkmcnt(14)
  v_mfma_f32_16x16x32_bf16 v[240:243], v[32:35], v[104:107], v[240:243]
  v_mfma_f32_16x16x32_bf16 v[244:247], v[32:35], v[108:111], v[244:247]
  s_barrier
  ds_read_b64_tr_b16 v[32:33], v3 offset:32768
  ds_read_b64_tr_b16 v[34:35], v3 offset:33792
  s_waitcnt lgkmcnt(14)
  v_mfma_f32_16x16x32_bf16 v[248:251], v[36:39], v[104:107], v[248:251]
  v_mfma_f32_16x16x32_bf16 v[252:255], v[36:39], v[108:111], v[252:255]
  ds_read_b64_tr_b16 v[36:37], v4 offset:32768
  ds_read_b64_tr_b16 v[38:39], v4 offset:33792
  s_waitcnt lgkmcnt(14)
  v_mfma_f32_16x16x32_bf16 v[40:43], v[88:91], v[104:107], v[40:43]
  v_mfma_f32_16x16x32_bf16 v[44:47], v[88:91], v[108:111], v[44:47]
  ds_read_b64_tr_b16 v[88:89], v3 offset:33024
  ds_read_b64_tr_b16 v[90:91], v3 offset:34048
  s_waitcnt lgkmcnt(14)
  v_mfma_f32_16x16x32_bf16 v[48:51], v[92:95], v[104:107], v[48:51]
  v_mfma_f32_16x16x32_bf16 v[52:55], v[92:95], v[108:111], v[52:55]
  ds_read_b64_tr_b16 v[92:93], v4 offset:33024
  ds_read_b64_tr_b16 v[94:95], v4 offset:34048
  s_waitcnt lgkmcnt(14)
  v_mfma_f32_16x16x32_bf16 v[56:59], v[16:19], v[104:107], v[56:59]
  v_mfma_f32_16x16x32_bf16 v[60:63], v[16:19], v[108:111], v[60:63]
  ds_read_b64_tr_b16 v[16:17], v3 offset:33280
  ds_read_b64_tr_b16 v[18:19], v3 offset:34304
  s_waitcnt lgkmcnt(14)
  v_mfma_f32_16x16x32_bf16 v[64:67], v[20:23], v[104:107], v[64:67]
  v_mfma_f32_16x16x32_bf16 v[68:71], v[20:23], v[108:111], v[68:71]
  ds_read_b64_tr_b16 v[20:21], v4 offset:33280
  ds_read_b64_tr_b16 v[22:23], v4 offset:34304
  s_waitcnt lgkmcnt(14)
  v_mfma_f32_16x16x32_bf16 v[72:75], v[24:27], v[104:107], v[72:75]
  v_mfma_f32_16x16x32_bf16 v[76:79], v[24:27], v[108:111], v[76:79]
  ds_read_b64_tr_b16 v[24:25], v3 offset:33536
  ds_read_b64_tr_b16 v[26:27], v3 offset:34560
  s_waitcnt lgkmcnt(14)
  v_mfma_f32_16x16x32_bf16 v[80:83], v[28:31], v[104:107], v[80:83]
  v_mfma_f32_16x16x32_bf16 v[84:87], v[28:31], v[108:111], v[84:87]
  ds_read_b64_tr_b16 v[28:29], v4 offset:33536
  ds_read_b64_tr_b16 v[30:31], v4 offset:34560
  s_waitcnt vmcnt(2)
  s_waitcnt lgkmcnt(14)
  v_mfma_f32_16x16x32_bf16 v[192:195], v[32:35], v[112:115], v[192:195]
  v_mfma_f32_16x16x32_bf16 v[196:199], v[32:35], v[116:119], v[196:199]
  ds_read_b64_tr_b16 v[32:33], v5 offset:32768
  ds_read_b64_tr_b16 v[34:35], v5 offset:33280
  s_cmp_lg_u32 s3, 4
  s_cbranch_scc1 L_sgk_11
  s_lshl_b32 s65, s60, 8
  s_add_u32 s65, s65, s61
  s_add_u32 s65, s65, 100728832
  s_mov_b64 exec, 1
  v_mov_b32 v0, 1
  buffer_store_byte v0, off, s[56:59], s65 sc1
  s_mov_b64 exec, -1
L_sgk_11:
  s_waitcnt lgkmcnt(14)
  v_mfma_f32_16x16x32_bf16 v[200:203], v[36:39], v[112:115], v[200:203]
  v_mfma_f32_16x16x32_bf16 v[204:207], v[36:39], v[116:119], v[204:207]
  ds_read_b64_tr_b16 v[36:37], v5 offset:36864
  ds_read_b64_tr_b16 v[38:39], v5 offset:37376
  s_waitcnt lgkmcnt(14)
  v_mfma_f32_16x16x32_bf16 v[208:211], v[88:91], v[112:115], v[208:211]
  v_mfma_f32_16x16x32_bf16 v[212:215], v[88:91], v[116:119], v[212:215]
  ds_read_b64_tr_b16 v[88:89], v6 offset:32768
  ds_read_b64_tr_b16 v[90:91], v6 offset:33280
  s_waitcnt lgkmcnt(14)
  v_mfma_f32_16x16x32_bf16 v[216:219], v[92:95], v[112:115], v[216:219]
  v_mfma_f32_16x16x32_bf16 v[220:223], v[92:95], v[116:119], v[220:223]
  ds_read_b64_tr_b16 v[92:93], v6 offset:36864
  ds_read_b64_tr_b16 v[94:95], v6 offset:37376
  s_waitcnt lgkmcnt(14)
  v_mfma_f32_16x16x32_bf16 v[224:227], v[16:19], v[112:115], v[224:227]
  v_mfma_f32_16x16x32_bf16 v[228:231], v[16:19], v[116:119], v[228:231]
  ds_read_b64_tr_b16 v[16:17], v5 offset:33024
  ds_read_b64_tr_b16 v[18:19], v5 offset:33536
  s_waitcnt lgkmcnt(14)
  v_mfma_f32_16x16x32_bf16 v[232:235], v[20:23], v[112:115], v[232:235]
  v_mfma_f32_16x16x32_bf16 v[236:239], v[20:23], v[116:119], v[236:239]
  ds_read_b64_tr_b16 v[20:21], v5 offset:37120
  ds_read_b64_tr_b16 v[22:23], v5 offset:37632
  s_waitcnt lgkmcnt(14)
  v_mfma_f32_16x16x32_bf16 v[240:243], v[24:27], v[112:115], v[240:243]
  v_mfma_f32_16x16x32_bf16 v[244:247], v[24:27], v[116:119], v[244:247]
  ds_read_b64_tr_b16 v[24:25], v3 offset:49152
  ds_read_b64_tr_b16 v[26:27], v3 offset:50176
  s_waitcnt lgkmcnt(14)
  v_mfma_f32_16x16x32_bf16 v[248:251], v[28:31], v[112:115], v[248:251]
  v_mfma_f32_16x16x32_bf16 v[252:255], v[28:31], v[116:119], v[252:255]
  ds_read_b64_tr_b16 v[28:29], v4 offset:49152
  ds_read_b64_tr_b16 v[30:31], v4 offset:50176
  s_waitcnt lgkmcnt(14)
  v_mfma_f32_16x16x32_bf16 v[40:43], v[32:35], v[112:115], v[40:43]
  v_mfma_f32_16x16x32_bf16 v[44:47], v[32:35], v[116:119], v[44:47]
  ds_read_b64_tr_b16 v[32:33], v3 offset:49408
  ds_read_b64_tr_b16 v[34:35], v3 offset:50432
  s_waitcnt lgkmcnt(14)
  v_mfma_f32_16x16x32_bf16 v[48:51], v[36:39], v[112:115], v[48:51]
  v_mfma_f32_16x16x32_bf16 v[52:55], v[36:39], v[116:119], v[52:55]
  ds_read_b64_tr_b16 v[36:37], v4 offset:49408
  ds_read_b64_tr_b16 v[38:39], v4 offset:50432
  s_waitcnt lgkmcnt(14)
  v_mfma_f32_16x16x32_bf16 v[56:59], v[88:91], v[112:115], v[56:59]
  v_mfma_f32_16x16x32_bf16 v[60:63], v[88:91], v[116:119], v[60:63]
  ds_read_b64_tr_b16 v[88:89], v3 offset:49664
  ds_read_b64_tr_b16 v[90:91], v3 offset:50688
  s_waitcnt lgkmcnt(14)
  v_mfma_f32_16x16x32_bf16 v[64:67], v[92:95], v[112:115], v[64:67]
  v_mfma_f32_16x16x32_bf16 v[68:71], v[92:95], v[116:119], v[68:71]
  ds_read_b64_tr_b16 v[92:93], v4 offset:49664
  ds_read_b64_tr_b16 v[94:95], v4 offset:50688
  s_waitcnt lgkmcnt(14)
  v_mfma_f32_16x16x32_bf16 v[72:75], v[16:19], v[112:115], v[72:75]
  v_mfma_f32_16x16x32_bf16 v[76:79], v[16:19], v[116:119], v[76:79]
  ds_read_b64_tr_b16 v[16:17], v3 offset:49920
  ds_read_b64_tr_b16 v[18:19], v3 offset:50944
  s_waitcnt lgkmcnt(14)
  v_mfma_f32_16x16x32_bf16 v[80:83], v[20:23], v[112:115], v[80:83]
  v_mfma_f32_16x16x32_bf16 v[84:87], v[20:23], v[116:119], v[84:87]
  ds_read_b64_tr_b16 v[20:21], v4 offset:49920
  ds_read_b64_tr_b16 v[22:23], v4 offset:50944
  s_waitcnt vmcnt(0)
  s_waitcnt lgkmcnt(14)
  v_mfma_f32_16x16x32_bf16 v[192:195], v[24:27], v[120:123], v[192:195]
  v_mfma_f32_16x16x32_bf16 v[196:199], v[24:27], v[124:127], v[196:199]
  ds_read_b64_tr_b16 v[24:25], v5 offset:49152
  ds_read_b64_tr_b16 v[26:27], v5 offset:49664
  s_waitcnt lgkmcnt(14)
  v_mfma_f32_16x16x32_bf16 v[200:203], v[28:31], v[120:123], v[200:203]
  v_mfma_f32_16x16x32_bf16 v[204:207], v[28:31], v[124:127], v[204:207]
  ds_read_b64_tr_b16 v[28:29], v5 offset:53248
  ds_read_b64_tr_b16 v[30:31], v5 offset:53760
  s_waitcnt lgkmcnt(14)
  v_mfma_f32_16x16x32_bf16 v[208:211], v[32:35], v[120:123], v[208:211]
  v_mfma_f32_16x16x32_bf16 v[212:215], v[32:35], v[124:127], v[212:215]
  ds_read_b64_tr_b16 v[32:33], v6 offset:49152
  ds_read_b64_tr_b16 v[34:35], v6 offset:49664
  s_waitcnt lgkmcnt(14)
  v_mfma_f32_16x16x32_bf16 v[216:219], v[36:39], v[120:123], v[216:219]
  v_mfma_f32_16x16x32_bf16 v[220:223], v[36:39], v[124:127], v[220:223]
  ds_read_b64_tr_b16 v[36:37], v6 offset:53248
  ds_read_b64_tr_b16 v[38:39], v6 offset:53760
  s_waitcnt lgkmcnt(14)
  v_mfma_f32_16x16x32_bf16 v[224:227], v[88:91], v[120:123], v[224:227]
  v_mfma_f32_16x16x32_bf16 v[228:231], v[88:91], v[124:127], v[228:231]
  ds_read_b64_tr_b16 v[88:89], v5 offset:49408
  ds_read_b64_tr_b16 v[90:91], v5 offset:49920
  s_waitcnt lgkmcnt(14)
  v_mfma_f32_16x16x32_bf16 v[232:235], v[92:95], v[120:123], v[232:235]
  v_mfma_f32_16x16x32_bf16 v[236:239], v[92:95], v[124:127], v[236:239]
  ds_read_b64_tr_b16 v[92:93], v5 offset:53504
  ds_read_b64_tr_b16 v[94:95], v5 offset:54016
  s_waitcnt lgkmcnt(14)
  v_mfma_f32_16x16x32_bf16 v[240:243], v[16:19], v[120:123], v[240:243]
  v_mfma_f32_16x16x32_bf16 v[244:247], v[16:19], v[124:127], v[244:247]
  s_waitcnt lgkmcnt(12)
  v_mfma_f32_16x16x32_bf16 v[248:251], v[20:23], v[120:123], v[248:251]
  v_mfma_f32_16x16x32_bf16 v[252:255], v[20:23], v[124:127], v[252:255]
  s_waitcnt lgkmcnt(10)
  v_mfma_f32_16x16x32_bf16 v[40:43], v[24:27], v[120:123], v[40:43]
  v_mfma_f32_16x16x32_bf16 v[44:47], v[24:27], v[124:127], v[44:47]
  s_waitcnt lgkmcnt(8)
  v_mfma_f32_16x16x32_bf16 v[48:51], v[28:31], v[120:123], v[48:51]
  v_mfma_f32_16x16x32_bf16 v[52:55], v[28:31], v[124:127], v[52:55]
  s_waitcnt lgkmcnt(6)
  v_mfma_f32_16x16x32_bf16 v[56:59], v[32:35], v[120:123], v[56:59]
  v_mfma_f32_16x16x32_bf16 v[60:63], v[32:35], v[124:127], v[60:63]
  s_waitcnt lgkmcnt(4)
  v_mfma_f32_16x16x32_bf16 v[64:67], v[36:39], v[120:123], v[64:67]
  v_mfma_f32_16x16x32_bf16 v[68:71], v[36:39], v[124:127], v[68:71]
  s_waitcnt lgkmcnt(2)
  v_mfma_f32_16x16x32_bf16 v[72:75], v[88:91], v[120:123], v[72:75]
  v_mfma_f32_16x16x32_bf16 v[76:79], v[88:91], v[124:127], v[76:79]
  s_waitcnt lgkmcnt(0)
  v_mfma_f32_16x16x32_bf16 v[80:83], v[92:95], v[120:123], v[80:83]
  v_mfma_f32_16x16x32_bf16 v[84:87], v[92:95], v[124:127], v[84:87]
  s_lshl_b32 s65, s60, 19
  s_add_u32 s66, s65, 2097152
  s_add_u32 s44, s40, s66
  s_addc_u32 s45, s41, 0
  s_lshl_b32 s46, s81, 14
  s_mov_b32 s47, 0x00020000
  s_add_u32 s66, s65, 18874368
  s_add_u32 s52, s40, s66
  s_addc_u32 s53, s41, 0
  s_lshl_b32 s54, s81, 14
  s_mov_b32 s55, 0x00020000
  s_lshl_b32 s68, s64, 12
  s_mov_b32 s69, s68
  s_mov_b32 s72, s68
  s_mov_b32 s73, s68
  s_cmp_lg_u32 s3, 4
  s_cbranch_scc1 L_wkvd_13
  s_lshl_b32 s65, s60, 8
  s_add_u32 s65, s65, 100728832
L_wkv_12:
  buffer_load_dwordx2 v[96:97], off, s[56:59], s65 sc1
  s_waitcnt vmcnt(0)
  v_and_b32 v96, v96, v97
  s_nop 0
  v_readfirstlane_b32 s66, v96
  s_cmp_eq_u32 s66, 0x01010101
  s_cbranch_scc1 L_wkvd_13
  s_sleep 8
  s_branch L_wkv_12
L_wkvd_13:
  s_barrier
  s_cmp_eq_u32 s63, 0
  s_cbranch_scc1 L_skB_14
  s_add_u32 m0, s72, 0
  s_add_u32 s72, s72, 16384
  buffer_load_dwordx4 v2, s[44:47], s68 offen offset:0 sc1 lds
  buffer_load_dwordx4 v2, s[44:47], s68 offen offset:1024 sc1 lds
  buffer_load_dwordx4 v2, s[44:47], s68 offen offset:2048 sc1 lds
  buffer_load_dwordx4 v2, s[44:47], s68 offen offset:3072 sc1 lds
  s_cmp_ge_u32 s72, 81920
  s_cselect_b32 s65, 81920, 0
  s_sub_u32 s72, s72, s65
  s_add_u32 s68, s68, 16384
  s_add_u32 m0, s72, 0
  s_add_u32 s72, s72, 16384
  buffer_load_dwordx4 v2, s[44:47], s68 offen offset:0 sc1 lds
  buffer_load_dwordx4 v2, s[44:47], s68 offen offset:1024 sc1 lds
  buffer_load_dwordx4 v2, s[44:47], s68 offen offset:2048 sc1 lds
  buffer_load_dwordx4 v2, s[44:47], s68 offen offset:3072 sc1 lds
  s_cmp_ge_u32 s72, 81920
  s_cselect_b32 s65, 81920, 0
  s_sub_u32 s72, s72, s65
  s_add_u32 s68, s68, 16384
  s_add_u32 m0, s72, 0
  s_add_u32 s72, s72, 16384
  buffer_load_dwordx4 v2, s[44:47], s68 offen offset:0 sc1 lds
  buffer_load_dwordx4 v2, s[44:47], s68 offen offset:1024 sc1 lds
  buffer_load_dwordx4 v2, s[44:47], s68 offen offset:2048 sc1 lds
  buffer_load_dwordx4 v2, s[44:47], s68 offen offset:3072 sc1 lds
  s_cmp_ge_u32 s72, 81920
  s_cselect_b32 s65, 81920, 0
  s_sub_u32 s72, s72, s65
  s_add_u32 s68, s68, 16384
  s_add_u32 m0, s72, 0
  s_add_u32 s72, s72, 16384
  buffer_load_dwordx4 v2, s[44:47], s68 offen offset:0 sc1 lds
  buffer_load_dwordx4 v2, s[44:47], s68 offen offset:1024 sc1 lds
  buffer_load_dwordx4 v2, s[44:47], s68 offen offset:2048 sc1 lds
  buffer_load_dwordx4 v2, s[44:47], s68 offen offset:3072 sc1 lds
  s_cmp_ge_u32 s72, 81920
  s_cselect_b32 s65, 81920, 0
  s_sub_u32 s72, s72, s65
  s_add_u32 s68, s68, 16384
  s_add_u32 m0, s73, 81920
  s_add_u32 s73, s73, 16384
  buffer_load_dwordx4 v2, s[52:55], s69 offen offset:0 sc1 lds
  buffer_load_dwordx4 v2, s[52:55], s69 offen offset:1024 sc1 lds
  buffer_load_dwordx4 v2, s[52:55], s69 offen offset:2048 sc1 lds
  buffer_load_dwordx4 v2, s[52:55], s69 offen offset:3072 sc1 lds
  s_cmp_ge_u32 s73, 81920
  s_cselect_b32 s65, 81920, 0
  s_sub_u32 s73, s73, s65
  s_add_u32 s69, s69, 16384
  s_add_u32 m0, s73, 81920
  s_add_u32 s73, s73, 16384
  buffer_load_dwordx4 v2, s[52:55], s69 offen offset:0 sc1 lds
  buffer_load_dwordx4 v2, s[52:55], s69 offen offset:1024 sc1 lds
  buffer_load_dwordx4 v2, s[52:55], s69 offen offset:2048 sc1 lds
  buffer_load_dwordx4 v2, s[52:55], s69 offen offset:3072 sc1 lds
  s_cmp_ge_u32 s73, 81920
  s_cselect_b32 s65, 81920, 0
  s_sub_u32 s73, s73, s65
  s_add_u32 s69, s69, 16384
  s_add_u32 m0, s73, 81920
  s_add_u32 s73, s73, 16384
  buffer_load_dwordx4 v2, s[52:55], s69 offen offset:0 sc1 lds
  buffer_load_dwordx4 v2, s[52:55], s69 offen offset:1024 sc1 lds
  buffer_load_dwordx4 v2, s[52:55], s69 offen offset:2048 sc1 lds
  buffer_load_dwordx4 v2, s[52:55], s69 offen offset:3072 sc1 lds
  s_cmp_ge_u32 s73, 81920
  s_cselect_b32 s65, 81920, 0
  s_sub_u32 s73, s73, s65
  s_add_u32 s69, s69, 16384
L_skB_14:
  s_mov_b32 s66, 0xbdd2d3e8
  v_mov_b32 v104, 0xc0135761
  s_mul_i32 s77, s60, 3
  s_mul_i32 s76, s83, 88064
  s_add_u32 s76, s76, 52428800
  s_cmp_ge_u32 s77, 86
  s_cbranch_scc1 L_gg_15
  v_mul_f32 v96, v40, v40
  v_mul_f32 v97, v41, v41
  v_mul_f32 v98, v42, v42
  v_mul_f32 v99, v43, v43
  v_mul_f32 v100, v44, v44
  v_mul_f32 v101, v45, v45
  v_mul_f32 v102, v46, v46
  v_mul_f32 v103, v47, v47
  v_fma_f32 v96, v96, s66, v104
  v_fma_f32 v97, v97, s66, v104
  v_fma_f32 v98, v98, s66, v104
  v_fma_f32 v99, v99, s66, v104
  v_fma_f32 v100, v100, s66, v104
  v_fma_f32 v101, v101, s66, v104
  v_fma_f32 v102, v102, s66, v104
  v_fma_f32 v103, v103, s66, v104
  v_mul_f32 v96, v96, v40
  v_mul_f32 v97, v97, v41
  v_mul_f32 v98, v98, v42
  v_mul_f32 v99, v99, v43
  v_mul_f32 v100, v100, v44
  v_mul_f32 v101, v101, v45
  v_mul_f32 v102, v102, v46
  v_mul_f32 v103, v103, v47
  v_exp_f32 v96, v96
  v_exp_f32 v97, v97
  v_exp_f32 v98, v98
  v_exp_f32 v99, v99
  v_exp_f32 v100, v100
  v_exp_f32 v101, v101
  v_exp_f32 v102, v102
  v_exp_f32 v103, v103
  v_add_f32 v96, 1.0, v96
  v_add_f32 v97, 1.0, v97
  v_add_f32 v98, 1.0, v98
  v_add_f32 v99, 1.0, v99
  v_add_f32 v100, 1.0, v100
  v_add_f32 v101, 1.0, v101
  v_add_f32 v102, 1.0, v102
  v_add_f32 v103, 1.0, v103
  v_rcp_f32 v96, v96
  v_rcp_f32 v97, v97
  v_rcp_f32 v98, v98
  v_rcp_f32 v99, v99
  v_rcp_f32 v100, v100
  v_rcp_f32 v101, v101
  v_rcp_f32 v102, v102
  v_rcp_f32 v103, v103
  v_mul_f32 v40, v40, v48
  v_mul_f32 v41, v41, v49
  v_mul_f32 v42, v42, v50
  v_mul_f32 v43, v43, v51
  v_mul_f32 v44, v44, v52
  v_mul_f32 v45, v45, v53
  v_mul_f32 v46, v46, v54
  v_mul_f32 v47, v47, v55
  v_mul_f32 v40, v40, v96
  v_mul_f32 v41, v41, v97
  v_mul_f32 v42, v42, v98
  v_mul_f32 v43, v43, v99
  v_mul_f32 v44, v44, v100
  v_mul_f32 v45, v45, v101
  v_mul_f32 v46, v46, v102
  v_mul_f32 v47, v47, v103
  v_cvt_pk_bf16_f32 v108, v40, v41
  v_cvt_pk_bf16_f32 v109, v42, v43
  v_cvt_pk_bf16_f32 v110, v44, v45
  v_cvt_pk_bf16_f32 v111, v46, v47
  s_add_u32 s67, s77, 0
  s_lshr_b32 s65, s67, 1
  s_lshl_b32 s65, s65, 10
  s_and_b32 s67, s67, 1
  s_lshl_b32 s67, s67, 3
  s_add_u32 s65, s65, s67
  s_add_u32 s65, s65, s76
  buffer_store_dwordx2 v[108:109], v2, s[56:59], s65 offen sc1
  s_add_u32 s65, s65, 44032
  buffer_store_dwordx2 v[110:111], v2, s[56:59], s65 offen sc1
L_gg_15:
  s_cmp_ge_u32 s77, 85
  s_cbranch_scc1 L_gg_16
  v_mul_f32 v96, v56, v56
  v_mul_f32 v97, v57, v57
  v_mul_f32 v98, v58, v58
  v_mul_f32 v99, v59, v59
  v_mul_f32 v100, v60, v60
  v_mul_f32 v101, v61, v61
  v_mul_f32 v102, v62, v62
  v_mul_f32 v103, v63, v63
  v_fma_f32 v96, v96, s66, v104
  v_fma_f32 v97, v97, s66, v104
  v_fma_f32 v98, v98, s66, v104
  v_fma_f32 v99, v99, s66, v104
  v_fma_f32 v100, v100, s66, v104
  v_fma_f32 v101, v101, s66, v104
  v_fma_f32 v102, v102, s66, v104
  v_fma_f32 v103, v103, s66, v104
  v_mul_f32 v96, v96, v56
  v_mul_f32 v97, v97, v57
  v_mul_f32 v98, v98, v58
  v_mul_f32 v99, v99, v59
  v_mul_f32 v100, v100, v60
  v_mul_f32 v101, v101, v61
  v_mul_f32 v102, v102, v62
  v_mul_f32 v103, v103, v63
  v_exp_f32 v96, v96
  v_exp_f32 v97, v97
  v_exp_f32 v98, v98
  v_exp_f32 v99, v99
  v_exp_f32 v100, v100
  v_exp_f32 v101, v101
  v_exp_f32 v102, v102
  v_exp_f32 v103, v103
  v_add_f32 v96, 1.0, v96
  v_add_f32 v97, 1.0, v97
  v_add_f32 v98, 1.0, v98
  v_add_f32 v99, 1.0, v99
  v_add_f32 v100, 1.0, v100
  v_add_f32 v101, 1.0, v101
  v_add_f32 v102, 1.0, v102
  v_add_f32 v103, 1.0, v103
  v_rcp_f32 v96, v96
  v_rcp_f32 v97, v97
  v_rcp_f32 v98, v98
  v_rcp_f32 v99, v99
  v_rcp_f32 v100, v100
  v_rcp_f32 v101, v101
  v_rcp_f32 v102, v102
  v_rcp_f32 v103, v103
  v_mul_f32 v56, v56, v64
  v_mul_f32 v57, v57, v65
  v_mul_f32 v58, v58, v66
  v_mul_f32 v59, v59, v67
  v_mul_f32 v60, v60, v68
  v_mul_f32 v61, v61, v69
  v_mul_f32 v62, v62, v70
  v_mul_f32 v63, v63, v71
  v_mul_f32 v56, v56, v96
  v_mul_f32 v57, v57, v97
  v_mul_f32 v58, v58, v98
  v_mul_f32 v59, v59, v99
  v_mul_f32 v60, v60, v100
  v_mul_f32 v61, v61, v101
  v_mul_f32 v62, v62, v102
  v_mul_f32 v63, v63, v103
  v_cvt_pk_bf16_f32 v112, v56, v57
  v_cvt_pk_bf16_f32 v113, v58, v59
  v_cvt_pk_bf16_f32 v114, v60, v61
  v_cvt_pk_bf16_f32 v115, v62, v63
  s_add_u32 s67, s77, 1
  s_lshr_b32 s65, s67, 1
  s_lshl_b32 s65, s65, 10
  s_and_b32 s67, s67, 1
  s_lshl_b32 s67, s67, 3
  s_add_u32 s65, s65, s67
  s_add_u32 s65, s65, s76
  buffer_store_dwordx2 v[112:113], v2, s[56:59], s65 offen sc1
  s_add_u32 s65, s65, 44032
  buffer_store_dwordx2 v[114:115], v2, s[56:59], s65 offen sc1
L_gg_16:
  s_cmp_ge_u32 s77, 84
  s_cbranch_scc1 L_gg_17
  v_mul_f32 v96, v72, v72
  v_mul_f32 v97, v73, v73
  v_mul_f32 v98, v74, v74
  v_mul_f32 v99, v75, v75
  v_mul_f32 v100, v76, v76
  v_mul_f32 v101, v77, v77
  v_mul_f32 v102, v78, v78
  v_mul_f32 v103, v79, v79
  v_fma_f32 v96, v96, s66, v104
  v_fma_f32 v97, v97, s66, v104
  v_fma_f32 v98, v98, s66, v104
  v_fma_f32 v99, v99, s66, v104
  v_fma_f32 v100, v100, s66, v104
  v_fma_f32 v101, v101, s66, v104
  v_fma_f32 v102, v102, s66, v104
  v_fma_f32 v103, v103, s66, v104
  v_mul_f32 v96, v96, v72
  v_mul_f32 v97, v97, v73
  v_mul_f32 v98, v98, v74
  v_mul_f32 v99, v99, v75
  v_mul_f32 v100, v100, v76
  v_mul_f32 v101, v101, v77
  v_mul_f32 v102, v102, v78
  v_mul_f32 v103, v103, v79
  v_exp_f32 v96, v96
  v_exp_f32 v97, v97
  v_exp_f32 v98, v98
  v_exp_f32 v99, v99
  v_exp_f32 v100, v100
  v_exp_f32 v101, v101
  v_exp_f32 v102, v102
  v_exp_f32 v103, v103
  v_add_f32 v96, 1.0, v96
  v_add_f32 v97, 1.0, v97
  v_add_f32 v98, 1.0, v98
  v_add_f32 v99, 1.0, v99
  v_add_f32 v100, 1.0, v100
  v_add_f32 v101, 1.0, v101
  v_add_f32 v102, 1.0, v102
  v_add_f32 v103, 1.0, v103
  v_rcp_f32 v96, v96
  v_rcp_f32 v97, v97
  v_rcp_f32 v98, v98
  v_rcp_f32 v99, v99
  v_rcp_f32 v100, v100
  v_rcp_f32 v101, v101
  v_rcp_f32 v102, v102
  v_rcp_f32 v103, v103
  v_mul_f32 v72, v72, v80
  v_mul_f32 v73, v73, v81
  v_mul_f32 v74, v74, v82
  v_mul_f32 v75, v75, v83
  v_mul_f32 v76, v76, v84
  v_mul_f32 v77, v77, v85
  v_mul_f32 v78, v78, v86
  v_mul_f32 v79, v79, v87
  v_mul_f32 v72, v72, v96
  v_mul_f32 v73, v73, v97
  v_mul_f32 v74, v74, v98
  v_mul_f32 v75, v75, v99
  v_mul_f32 v76, v76, v100
  v_mul_f32 v77, v77, v101
  v_mul_f32 v78, v78, v102
  v_mul_f32 v79, v79, v103
  v_cvt_pk_bf16_f32 v116, v72, v73
  v_cvt_pk_bf16_f32 v117, v74, v75
  v_cvt_pk_bf16_f32 v118, v76, v77
  v_cvt_pk_bf16_f32 v119, v78, v79
  s_add_u32 s67, s77, 2
  s_lshr_b32 s65, s67, 1
  s_lshl_b32 s65, s65, 10
  s_and_b32 s67, s67, 1
  s_lshl_b32 s67, s67, 3
  s_add_u32 s65, s65, s67
  s_add_u32 s65, s65, s76
  buffer_store_dwordx2 v[116:117], v2, s[56:59], s65 offen sc1
  s_add_u32 s65, s65, 44032
  buffer_store_dwordx2 v[118:119], v2, s[56:59], s65 offen sc1
L_gg_17:
  v_mov_b32 v96, 0x3e0293ee
  v_mov_b32 v97, 0x3e0293ee
  v_pk_mul_f32 v[192:193], v[192:193], v[96:97]
  v_pk_mul_f32 v[194:195], v[194:195], v[96:97]
  v_pk_mul_f32 v[196:197], v[196:197], v[96:97]
  v_pk_mul_f32 v[198:199], v[198:199], v[96:97]
  v_pk_mul_f32 v[200:201], v[200:201], v[96:97]
  v_pk_mul_f32 v[202:203], v[202:203], v[96:97]
  v_pk_mul_f32 v[204:205], v[204:205], v[96:97]
  v_pk_mul_f32 v[206:207], v[206:207], v[96:97]
  v_pk_mul_f32 v[208:209], v[208:209], v[96:97]
  v_pk_mul_f32 v[210:211], v[210:211], v[96:97]
  v_pk_mul_f32 v[212:213], v[212:213], v[96:97]
  v_pk_mul_f32 v[214:215], v[214:215], v[96:97]
  v_pk_mul_f32 v[216:217], v[216:217], v[96:97]
  v_pk_mul_f32 v[218:219], v[218:219], v[96:97]
  v_pk_mul_f32 v[220:221], v[220:221], v[96:97]
  v_pk_mul_f32 v[222:223], v[222:223], v[96:97]
  v_pk_mul_f32 v[224:225], v[224:225], v[96:97]
  v_pk_mul_f32 v[226:227], v[226:227], v[96:97]
  v_pk_mul_f32 v[228:229], v[228:229], v[96:97]
  v_pk_mul_f32 v[230:231], v[230:231], v[96:97]
  v_pk_mul_f32 v[232:233], v[232:233], v[96:97]
  v_pk_mul_f32 v[234:235], v[234:235], v[96:97]
  v_pk_mul_f32 v[236:237], v[236:237], v[96:97]
  v_pk_mul_f32 v[238:239], v[238:239], v[96:97]
  v_pk_mul_f32 v[240:241], v[240:241], v[96:97]
  v_pk_mul_f32 v[242:243], v[242:243], v[96:97]
  v_pk_mul_f32 v[244:245], v[244:245], v[96:97]
  v_pk_mul_f32 v[246:247], v[246:247], v[96:97]
  v_pk_mul_f32 v[248:249], v[248:249], v[96:97]
  v_pk_mul_f32 v[250:251], v[250:251], v[96:97]
  v_pk_mul_f32 v[252:253], v[252:253], v[96:97]
  v_pk_mul_f32 v[254:255], v[254:255], v[96:97]
  v_cvt_pk_bf16_f32 v32, v192, v193
  v_cvt_pk_bf16_f32 v33, v194, v195
  v_cvt_pk_bf16_f32 v34, v200, v201
  v_cvt_pk_bf16_f32 v35, v202, v203
  v_cvt_pk_bf16_f32 v36, v208, v209
  v_cvt_pk_bf16_f32 v37, v210, v211
  v_cvt_pk_bf16_f32 v38, v216, v217
  v_cvt_pk_bf16_f32 v39, v218, v219
  v_cvt_pk_bf16_f32 v40, v224, v225
  v_cvt_pk_bf16_f32 v41, v226, v227
  v_cvt_pk_bf16_f32 v42, v232, v233
  v_cvt_pk_bf16_f32 v43, v234, v235
  v_cvt_pk_bf16_f32 v44, v240, v241
  v_cvt_pk_bf16_f32 v45, v242, v243
  v_cvt_pk_bf16_f32 v46, v248, v249
  v_cvt_pk_bf16_f32 v47, v250, v251
  v_cvt_pk_bf16_f32 v48, v196, v197
  v_cvt_pk_bf16_f32 v49, v198, v199
  v_cvt_pk_bf16_f32 v50, v204, v205
  v_cvt_pk_bf16_f32 v51, v206, v207
  v_cvt_pk_bf16_f32 v52, v212, v213
  v_cvt_pk_bf16_f32 v53, v214, v215
  v_cvt_pk_bf16_f32 v54, v220, v221
  v_cvt_pk_bf16_f32 v55, v222, v223
  v_cvt_pk_bf16_f32 v56, v228, v229
  v_cvt_pk_bf16_f32 v57, v230, v231
  v_cvt_pk_bf16_f32 v58, v236, v237
  v_cvt_pk_bf16_f32 v59, v238, v239
  v_cvt_pk_bf16_f32 v60, v244, v245
  v_cvt_pk_bf16_f32 v61, v246, v247
  v_cvt_pk_bf16_f32 v62, v252, v253
  v_cvt_pk_bf16_f32 v63, v254, v255
  v_lshrrev_b32 v15, 4, v1
  v_lshlrev_b32 v15, 2, v15
  v_and_b32 v5, 15, v1
  v_sub_u32 v5, v5, v15
  v_cmp_gt_i32 s[8:9], 0, v5
  v_cmp_gt_i32 s[10:11], 1, v5
  v_cmp_gt_i32 s[12:13], 2, v5
  v_cmp_gt_i32 s[14:15], 3, v5
  v_mov_b32 v8, 0xff800000
  v_mov_b32 v9, 0
  v_mov_b32 v10, 0
  v_mov_b32 v176, 0
  v_mov_b32 v177, 0
  v_mov_b32 v178, 0
  v_mov_b32 v179, 0
  v_mov_b32 v180, 0
  v_mov_b32 v181, 0
  v_mov_b32 v182, 0
  v_mov_b32 v183, 0
  v_mov_b32 v184, 0
  v_mov_b32 v185, 0
  v_mov_b32 v186, 0
  v_mov_b32 v187, 0
  v_mov_b32 v188, 0
  v_mov_b32 v189, 0
  v_mov_b32 v190, 0
  v_mov_b32 v191, 0
  v_mov_b32 v192, 0
  v_mov_b32 v193, 0
  v_mov_b32 v194, 0
  v_mov_b32 v195, 0
  v_mov_b32 v196, 0
  v_mov_b32 v197, 0
  v_mov_b32 v198, 0
  v_mov_b32 v199, 0
  v_mov_b32 v200, 0
  v_mov_b32 v201, 0
  v_mov_b32 v202, 0
  v_mov_b32 v203, 0
  v_mov_b32 v204, 0
  v_mov_b32 v205, 0
  v_mov_b32 v206, 0
  v_mov_b32 v207, 0
  v_mov_b32 v208, 0
  v_mov_b32 v209, 0
  v_mov_b32 v210, 0
  v_mov_b32 v211, 0
  v_mov_b32 v212, 0
  v_mov_b32 v213, 0
  v_mov_b32 v214, 0
  v_mov_b32 v215, 0
  v_mov_b32 v216, 0
  v_mov_b32 v217, 0
  v_mov_b32 v218, 0
  v_mov_b32 v219, 0
  v_mov_b32 v220, 0
  v_mov_b32 v221, 0
  v_mov_b32 v222, 0
  v_mov_b32 v223, 0
  v_mov_b32 v224, 0
  v_mov_b32 v225, 0
  v_mov_b32 v226, 0
  v_mov_b32 v227, 0
  v_mov_b32 v228, 0
  v_mov_b32 v229, 0
  v_mov_b32 v230, 0
  v_mov_b32 v231, 0
  v_mov_b32 v232, 0
  v_mov_b32 v233, 0
  v_mov_b32 v234, 0
  v_mov_b32 v235, 0
  v_mov_b32 v236, 0
  v_mov_b32 v237, 0
  v_mov_b32 v238, 0
  v_mov_b32 v239, 0
  v_add_u32 v3, 0, v2
  v_add_u32 v4, 81920, v2
  s_mov_b32 s75, 0
  s_mov_b32 s76, 81920
  s_waitcnt vmcnt(20)
  s_barrier
  s_mov_b32 s74, -1
  ds_read_b128 v[80:83], v3 offset:0
  ds_read_b128 v[84:87], v3 offset:1024
  ds_read_b128 v[88:91], v3 offset:2048
  ds_read_b128 v[92:95], v3 offset:3072
  ds_read_b128 v[96:99], v3 offset:4096
  ds_read_b128 v[100:103], v3 offset:5120
  ds_read_b128 v[104:107], v3 offset:6144
  ds_read_b128 v[108:111], v3 offset:7168
  s_waitcnt lgkmcnt(4)
  v_mfma_f32_16x16x32_bf16 v[112:115], v[80:83], v[32:35], 0
  v_mfma_f32_16x16x32_bf16 v[116:119], v[80:83], v[48:51], 0
  ds_read_b128 v[80:83], v3 offset:8192
  v_mfma_f32_16x16x32_bf16 v[112:115], v[84:87], v[36:39], v[112:115]
  v_mfma_f32_16x16x32_bf16 v[116:119], v[84:87], v[52:55], v[116:119]
  ds_read_b128 v[84:87], v3 offset:9216
  v_mfma_f32_16x16x32_bf16 v[112:115], v[88:91], v[40:43], v[112:115]
  v_mfma_f32_16x16x32_bf16 v[116:119], v[88:91], v[56:59], v[116:119]
  ds_read_b128 v[88:91], v3 offset:10240
  v_mfma_f32_16x16x32_bf16 v[112:115], v[92:95], v[44:47], v[112:115]
  v_mfma_f32_16x16x32_bf16 v[116:119], v[92:95], v[60:63], v[116:119]
  ds_read_b128 v[92:95], v3 offset:11264
  s_waitcnt lgkmcnt(4)
  v_mfma_f32_16x16x32_bf16 v[120:123], v[96:99], v[32:35], 0
  v_mfma_f32_16x16x32_bf16 v[124:127], v[96:99], v[48:51], 0
  ds_read_b128 v[96:99], v3 offset:12288
  v_mfma_f32_16x16x32_bf16 v[120:123], v[100:103], v[36:39], v[120:123]
  v_mfma_f32_16x16x32_bf16 v[124:127], v[100:103], v[52:55], v[124:127]
  ds_read_b128 v[100:103], v3 offset:13312
  v_mfma_f32_16x16x32_bf16 v[120:123], v[104:107], v[40:43], v[120:123]
  v_mfma_f32_16x16x32_bf16 v[124:127], v[104:107], v[56:59], v[124:127]
  ds_read_b128 v[104:107], v3 offset:14336
  v_mfma_f32_16x16x32_bf16 v[120:123], v[108:111], v[44:47], v[120:123]
  v_mfma_f32_16x16x32_bf16 v[124:127], v[108:111], v[60:63], v[124:127]
  ds_read_b128 v[108:111], v3 offset:15360
  s_waitcnt lgkmcnt(4)
  v_mfma_f32_16x16x32_bf16 v[128:131], v[80:83], v[32:35], 0
  v_mfma_f32_16x16x32_bf16 v[132:135], v[80:83], v[48:51], 0
  s_add_u32 s75, s75, 16384
  s_cmp_ge_u32 s75, 81920
  s_cselect_b32 s75, 0, s75
  v_add_u32 v3, s75, v2
  ds_read_b128 v[80:83], v3 offset:0
  v_mfma_f32_16x16x32_bf16 v[128:131], v[84:87], v[36:39], v[128:131]
  v_mfma_f32_16x16x32_bf16 v[132:135], v[84:87], v[52:55], v[132:135]
  ds_read_b128 v[84:87], v3 offset:1024
  v_mfma_f32_16x16x32_bf16 v[128:131], v[88:91], v[40:43], v[128:131]
  v_mfma_f32_16x16x32_bf16 v[132:135], v[88:91], v[56:59], v[132:135]
  ds_read_b128 v[88:91], v3 offset:2048
  v_mfma_f32_16x16x32_bf16 v[128:131], v[92:95], v[44:47], v[128:131]
  v_mfma_f32_16x16x32_bf16 v[132:135], v[92:95], v[60:63], v[132:135]
  ds_read_b128 v[92:95], v3 offset:3072
  s_waitcnt lgkmcnt(4)
  v_mfma_f32_16x16x32_bf16 v[136:139], v[96:99], v[32:35], 0
  v_mfma_f32_16x16x32_bf16 v[140:143], v[96:99], v[48:51], 0
  ds_read_b128 v[96:99], v3 offset:4096
  v_mfma_f32_16x16x32_bf16 v[136:139], v[100:103], v[36:39], v[136:139]
  v_mfma_f32_16x16x32_bf16 v[140:143], v[100:103], v[52:55], v[140:143]
  ds_read_b128 v[100:103], v3 offset:5120
  v_mfma_f32_16x16x32_bf16 v[136:139], v[104:107], v[40:43], v[136:139]
  v_mfma_f32_16x16x32_bf16 v[140:143], v[104:107], v[56:59], v[140:143]
  ds_read_b128 v[104:107], v3 offset:6144
  v_mfma_f32_16x16x32_bf16 v[136:139], v[108:111], v[44:47], v[136:139]
  v_mfma_f32_16x16x32_bf16 v[140:143], v[108:111], v[60:63], v[140:143]
  ds_read_b128 v[108:111], v3 offset:7168
  s_nop 7
  s_cmp_eq_u32 s82, 2
  s_cbranch_scc1 L_at_mask_f
L_at_maskret_f:
  v_max3_f32 v240, v112, v113, v114
  v_max3_f32 v240, v240, v115, v120
  v_max3_f32 v240, v240, v121, v122
  v_max3_f32 v240, v240, v123, v128
  v_max3_f32 v240, v240, v129, v130
  v_max3_f32 v240, v240, v131, v136
  v_max3_f32 v240, v240, v137, v138
  v_max_f32 v240, v240, v139
  v_mov_b32 v247, v240
  s_nop 1
  v_permlane16_swap_b32 v240, v247
  v_max_f32 v240, v240, v247
  v_mov_b32 v247, v240
  s_nop 1
  v_permlane32_swap_b32 v240, v247
  v_max_f32 v240, v240, v247
  v_sub_f32 v112, v112, v240
  v_sub_f32 v113, v113, v240
  v_sub_f32 v114, v114, v240
  v_sub_f32 v115, v115, v240
  v_sub_f32 v120, v120, v240
  v_sub_f32 v121, v121, v240
  v_sub_f32 v122, v122, v240
  v_sub_f32 v123, v123, v240
  v_sub_f32 v128, v128, v240
  v_sub_f32 v129, v129, v240
  v_sub_f32 v130, v130, v240
  v_sub_f32 v131, v131, v240
  v_sub_f32 v136, v136, v240
  v_sub_f32 v137, v137, v240
  v_sub_f32 v138, v138, v240
  v_sub_f32 v139, v139, v240
  v_sub_f32 v16, 0, v240
  v_sub_f32 v17, 0, v240
  v_sub_f32 v18, 0, v240
  v_sub_f32 v19, 0, v240
  v_max3_f32 v240, v116, v117, v118
  v_max3_f32 v240, v240, v119, v124
  v_max3_f32 v240, v240, v125, v126
  v_max3_f32 v240, v240, v127, v132
  v_max3_f32 v240, v240, v133, v134
  v_max3_f32 v240, v240, v135, v140
  v_max3_f32 v240, v240, v141, v142
  v_max_f32 v240, v240, v143
  v_mov_b32 v247, v240
  s_nop 1
  v_permlane16_swap_b32 v240, v247
  v_max_f32 v240, v240, v247
  v_mov_b32 v247, v240
  s_nop 1
  v_permlane32_swap_b32 v240, v247
  v_max_f32 v240, v240, v247
  v_sub_f32 v116, v116, v240
  v_sub_f32 v117, v117, v240
  v_sub_f32 v118, v118, v240
  v_sub_f32 v119, v119, v240
  v_sub_f32 v124, v124, v240
  v_sub_f32 v125, v125, v240
  v_sub_f32 v126, v126, v240
  v_sub_f32 v127, v127, v240
  v_sub_f32 v132, v132, v240
  v_sub_f32 v133, v133, v240
  v_sub_f32 v134, v134, v240
  v_sub_f32 v135, v135, v240
  v_sub_f32 v140, v140, v240
  v_sub_f32 v141, v141, v240
  v_sub_f32 v142, v142, v240
  v_sub_f32 v143, v143, v240
  v_sub_f32 v20, 0, v240
  v_sub_f32 v21, 0, v240
  v_sub_f32 v22, 0, v240
  v_sub_f32 v23, 0, v240
  s_mov_b32 s74, 0
  s_waitcnt vmcnt(0)
  s_cmp_lg_u32 s63, 0
  s_cbranch_scc1 L_two_18
  s_lshl_b32 s66, s3, 12
  s_add_u32 m0, s66, 131072
  s_lshl_b32 s66, s2, 2
  s_add_u32 s66, s66, s3
  s_mov_b32 s48, s26
  s_mov_b32 s49, s27
  s_mov_b32 s50, 4194304
  s_mov_b32 s51, 0x00020000
  s_lshl_b32 s65, s66, 12
  buffer_load_dwordx4 v[248:251], v2, s[48:51], s65 offen offset:0
  buffer_load_dwordx4 v[248:251], v2, s[48:51], s65 offen offset:1024
  buffer_load_dwordx4 v[248:251], v2, s[48:51], s65 offen offset:2048
  buffer_load_dwordx4 v[248:251], v2, s[48:51], s65 offen offset:3072
  s_mov_b32 s48, s34
  s_mov_b32 s49, s35
  s_mov_b32 s50, 1409024
  s_mov_b32 s51, 0x00020000
  s_lshl_b32 s65, s66, 11
  buffer_load_dwordx4 v[248:251], v2, s[48:51], s65 offen offset:0
  buffer_load_dwordx4 v[248:251], v2, s[48:51], s65 offen offset:1024
L_two_18:
L_at_loop:
  s_cmp_eq_u32 s63, 0
  s_cbranch_scc1 L_at_bA_e
  s_waitcnt vmcnt(4)
  s_barrier
  s_add_u32 m0, s72, 0
  s_add_u32 s72, s72, 16384
  buffer_load_dwordx4 v2, s[44:47], s68 offen offset:0 sc1 lds
  buffer_load_dwordx4 v2, s[44:47], s68 offen offset:1024 sc1 lds
  buffer_load_dwordx4 v2, s[44:47], s68 offen offset:2048 sc1 lds
  buffer_load_dwordx4 v2, s[44:47], s68 offen offset:3072 sc1 lds
  s_cmp_ge_u32 s72, 81920
  s_cselect_b32 s65, 81920, 0
  s_sub_u32 s72, s72, s65
  s_add_u32 s68, s68, 16384
  s_add_u32 m0, s72, 0
  s_add_u32 s72, s72, 16384
  buffer_load_dwordx4 v2, s[44:47], s68 offen offset:0 sc1 lds
  buffer_load_dwordx4 v2, s[44:47], s68 offen offset:1024 sc1 lds
  buffer_load_dwordx4 v2, s[44:47], s68 offen offset:2048 sc1 lds
  buffer_load_dwordx4 v2, s[44:47], s68 offen offset:3072 sc1 lds
  s_cmp_ge_u32 s72, 81920
  s_cselect_b32 s65, 81920, 0
  s_sub_u32 s72, s72, s65
  s_add_u32 s68, s68, 16384
  s_add_u32 m0, s73, 81920
  s_add_u32 s73, s73, 16384
  buffer_load_dwordx4 v2, s[52:55], s69 offen offset:0 sc1 lds
  buffer_load_dwordx4 v2, s[52:55], s69 offen offset:1024 sc1 lds
  buffer_load_dwordx4 v2, s[52:55], s69 offen offset:2048 sc1 lds
  buffer_load_dwordx4 v2, s[52:55], s69 offen offset:3072 sc1 lds
  s_cmp_ge_u32 s73, 81920
  s_cselect_b32 s65, 81920, 0
  s_sub_u32 s73, s73, s65
  s_add_u32 s69, s69, 16384
  s_add_u32 m0, s73, 81920
  s_add_u32 s73, s73, 16384
  buffer_load_dwordx4 v2, s[52:55], s69 offen offset:0 sc1 lds
  buffer_load_dwordx4 v2, s[52:55], s69 offen offset:1024 sc1 lds
  buffer_load_dwordx4 v2, s[52:55], s69 offen offset:2048 sc1 lds
  buffer_load_dwordx4 v2, s[52:55], s69 offen offset:3072 sc1 lds
  s_cmp_ge_u32 s73, 81920
  s_cselect_b32 s65, 81920, 0
  s_sub_u32 s73, s73, s65
  s_add_u32 s69, s69, 16384
  s_branch L_at_bJ_e
L_at_bA_e:
  s_barrier
L_at_bJ_e:
  s_waitcnt lgkmcnt(4)
  v_mfma_f32_16x16x32_bf16 v[144:147], v[80:83], v[32:35], v[16:19]
  v_exp_f32 v24, v112
  v_mfma_f32_16x16x32_bf16 v[148:151], v[80:83], v[48:51], v[20:23]
  ds_read_b128 v[80:83], v3 offset:8192
  v_exp_f32 v25, v113
  v_mfma_f32_16x16x32_bf16 v[144:147], v[84:87], v[36:39], v[144:147]
  v_exp_f32 v26, v114
  v_exp_f32 v27, v115
  v_mfma_f32_16x16x32_bf16 v[148:151], v[84:87], v[52:55], v[148:151]
  ds_read_b128 v[84:87], v3 offset:9216
  v_add_f32 v9, v9, v24
  v_cvt_pk_bf16_f32 v64, v24, v25
  v_mfma_f32_16x16x32_bf16 v[144:147], v[88:91], v[40:43], v[144:147]
  v_add_f32 v9, v9, v25
  v_exp_f32 v28, v116
  v_mfma_f32_16x16x32_bf16 v[148:151], v[88:91], v[56:59], v[148:151]
  ds_read_b128 v[88:91], v3 offset:10240
  v_exp_f32 v29, v117
  v_mfma_f32_16x16x32_bf16 v[144:147], v[92:95], v[44:47], v[144:147]
  v_add_f32 v9, v9, v26
  v_cvt_pk_bf16_f32 v65, v26, v27
  v_mfma_f32_16x16x32_bf16 v[148:151], v[92:95], v[60:63], v[148:151]
  ds_read_b128 v[92:95], v3 offset:11264
  v_add_f32 v9, v9, v27
  v_exp_f32 v30, v118
  s_waitcnt lgkmcnt(4)
  v_mfma_f32_16x16x32_bf16 v[152:155], v[96:99], v[32:35], v[16:19]
  v_exp_f32 v31, v119
  v_mfma_f32_16x16x32_bf16 v[156:159], v[96:99], v[48:51], v[20:23]
  ds_read_b128 v[96:99], v3 offset:12288
  v_add_f32 v10, v10, v28
  v_cvt_pk_bf16_f32 v68, v28, v29
  v_add_f32 v10, v10, v29
  v_mfma_f32_16x16x32_bf16 v[152:155], v[100:103], v[36:39], v[152:155]
  v_exp_f32 v24, v120
  v_mfma_f32_16x16x32_bf16 v[156:159], v[100:103], v[52:55], v[156:159]
  ds_read_b128 v[100:103], v3 offset:13312
  v_exp_f32 v25, v121
  v_add_f32 v10, v10, v30
  v_mfma_f32_16x16x32_bf16 v[152:155], v[104:107], v[40:43], v[152:155]
  v_cvt_pk_bf16_f32 v69, v30, v31
  v_add_f32 v10, v10, v31
  v_mfma_f32_16x16x32_bf16 v[156:159], v[104:107], v[56:59], v[156:159]
  ds_read_b128 v[104:107], v3 offset:14336
  v_exp_f32 v26, v122
  v_mfma_f32_16x16x32_bf16 v[152:155], v[108:111], v[44:47], v[152:155]
  v_exp_f32 v27, v123
  v_add_f32 v9, v9, v24
  v_mfma_f32_16x16x32_bf16 v[156:159], v[108:111], v[60:63], v[156:159]
  ds_read_b128 v[108:111], v3 offset:15360
  v_cvt_pk_bf16_f32 v66, v24, v25
  v_add_f32 v9, v9, v25
  s_waitcnt lgkmcnt(4)
  v_mfma_f32_16x16x32_bf16 v[160:163], v[80:83], v[32:35], v[16:19]
  v_exp_f32 v28, v124
  v_exp_f32 v29, v125
  v_mfma_f32_16x16x32_bf16 v[164:167], v[80:83], v[48:51], v[20:23]
  ds_read_b128 v[80:83], v4 offset:0
  v_add_f32 v9, v9, v26
  v_cvt_pk_bf16_f32 v67, v26, v27
  v_mfma_f32_16x16x32_bf16 v[160:163], v[84:87], v[36:39], v[160:163]
  v_add_f32 v9, v9, v27
  v_exp_f32 v30, v126
  v_mfma_f32_16x16x32_bf16 v[164:167], v[84:87], v[52:55], v[164:167]
  ds_read_b128 v[84:87], v4 offset:1024
  v_exp_f32 v31, v127
  v_mfma_f32_16x16x32_bf16 v[160:163], v[88:91], v[40:43], v[160:163]
  v_add_f32 v10, v10, v28
  v_cvt_pk_bf16_f32 v70, v28, v29
  v_mfma_f32_16x16x32_bf16 v[164:167], v[88:91], v[56:59], v[164:167]
  ds_read_b128 v[88:91], v4 offset:2048
  v_add_f32 v10, v10, v29
  v_exp_f32 v24, v128
  v_mfma_f32_16x16x32_bf16 v[160:163], v[92:95], v[44:47], v[160:163]
  v_exp_f32 v25, v129
  v_mfma_f32_16x16x32_bf16 v[164:167], v[92:95], v[60:63], v[164:167]
  ds_read_b128 v[92:95], v4 offset:3072
  v_add_f32 v10, v10, v30
  v_cvt_pk_bf16_f32 v71, v30, v31
  v_add_f32 v10, v10, v31
  s_waitcnt lgkmcnt(4)
  v_mfma_f32_16x16x32_bf16 v[168:171], v[96:99], v[32:35], v[16:19]
  v_exp_f32 v26, v130
  v_mfma_f32_16x16x32_bf16 v[172:175], v[96:99], v[48:51], v[20:23]
  ds_read_b128 v[96:99], v4 offset:4096
  v_exp_f32 v27, v131
  v_add_f32 v9, v9, v24
  v_mfma_f32_16x16x32_bf16 v[168:171], v[100:103], v[36:39], v[168:171]
  v_cvt_pk_bf16_f32 v72, v24, v25
  v_add_f32 v9, v9, v25
  v_mfma_f32_16x16x32_bf16 v[172:175], v[100:103], v[52:55], v[172:175]
  ds_read_b128 v[100:103], v4 offset:5120
  v_exp_f32 v28, v132
  v_mfma_f32_16x16x32_bf16 v[168:171], v[104:107], v[40:43], v[168:171]
  v_exp_f32 v29, v133
  v_add_f32 v9, v9, v26
  v_mfma_f32_16x16x32_bf16 v[172:175], v[104:107], v[56:59], v[172:175]
  ds_read_b128 v[104:107], v4 offset:6144
  v_cvt_pk_bf16_f32 v73, v26, v27
  v_add_f32 v9, v9, v27
  v_mfma_f32_16x16x32_bf16 v[168:171], v[108:111], v[44:47], v[168:171]
  v_exp_f32 v30, v134
  v_exp_f32 v31, v135
  v_mfma_f32_16x16x32_bf16 v[172:175], v[108:111], v[60:63], v[172:175]
  ds_read_b128 v[108:111], v4 offset:7168
  v_add_f32 v10, v10, v28
  v_cvt_pk_bf16_f32 v76, v28, v29
  s_waitcnt lgkmcnt(4)
  v_mfma_f32_16x16x32_bf16 v[176:179], v[80:83], v[64:67], v[176:179]
  v_add_f32 v10, v10, v29
  v_exp_f32 v24, v136
  v_mfma_f32_16x16x32_bf16 v[180:183], v[80:83], v[68:71], v[180:183]
  ds_read_b128 v[80:83], v4 offset:8192
  v_exp_f32 v25, v137
  v_mfma_f32_16x16x32_bf16 v[184:187], v[84:87], v[64:67], v[184:187]
  v_add_f32 v10, v10, v30
  v_cvt_pk_bf16_f32 v77, v30, v31
  v_mfma_f32_16x16x32_bf16 v[188:191], v[84:87], v[68:71], v[188:191]
  ds_read_b128 v[84:87], v4 offset:9216
  v_add_f32 v10, v10, v31
  v_exp_f32 v26, v138
  v_mfma_f32_16x16x32_bf16 v[192:195], v[88:91], v[64:67], v[192:195]
  v_exp_f32 v27, v139
  v_mfma_f32_16x16x32_bf16 v[196:199], v[88:91], v[68:71], v[196:199]
  ds_read_b128 v[88:91], v4 offset:10240
  v_add_f32 v9, v9, v24
  v_cvt_pk_bf16_f32 v74, v24, v25
  v_add_f32 v9, v9, v25
  v_mfma_f32_16x16x32_bf16 v[200:203], v[92:95], v[64:67], v[200:203]
  v_exp_f32 v28, v140
  v_mfma_f32_16x16x32_bf16 v[204:207], v[92:95], v[68:71], v[204:207]
  ds_read_b128 v[92:95], v4 offset:11264
  v_exp_f32 v29, v141
  v_add_f32 v9, v9, v26
  s_waitcnt lgkmcnt(4)
  v_mfma_f32_16x16x32_bf16 v[208:211], v[96:99], v[64:67], v[208:211]
  v_cvt_pk_bf16_f32 v75, v26, v27
  v_add_f32 v9, v9, v27
  v_mfma_f32_16x16x32_bf16 v[212:215], v[96:99], v[68:71], v[212:215]
  ds_read_b128 v[96:99], v4 offset:12288
  v_exp_f32 v30, v142
  v_mfma_f32_16x16x32_bf16 v[216:219], v[100:103], v[64:67], v[216:219]
  v_exp_f32 v31, v143
  v_add_f32 v10, v10, v28
  v_mfma_f32_16x16x32_bf16 v[220:223], v[100:103], v[68:71], v[220:223]
  ds_read_b128 v[100:103], v4 offset:13312
  v_cvt_pk_bf16_f32 v78, v28, v29
  v_add_f32 v10, v10, v29
  v_add_f32 v10, v10, v30
  v_mfma_f32_16x16x32_bf16 v[224:227], v[104:107], v[64:67], v[224:227]
  v_cvt_pk_bf16_f32 v79, v30, v31
  v_add_f32 v10, v10, v31
  v_mfma_f32_16x16x32_bf16 v[228:231], v[104:107], v[68:71], v[228:231]
  ds_read_b128 v[104:107], v4 offset:14336
  v_mfma_f32_16x16x32_bf16 v[232:235], v[108:111], v[64:67], v[232:235]
  s_add_u32 s75, s75, 16384
  s_cmp_ge_u32 s75, 81920
  s_cselect_b32 s75, 0, s75
  v_add_u32 v3, s75, v2
  v_mfma_f32_16x16x32_bf16 v[236:239], v[108:111], v[68:71], v[236:239]
  ds_read_b128 v[108:111], v4 offset:15360
  s_waitcnt lgkmcnt(4)
  v_mfma_f32_16x16x32_bf16 v[176:179], v[80:83], v[72:75], v[176:179]
  s_add_u32 s76, s76, 16384
  s_cmp_ge_u32 s76, 163840
  s_cselect_b32 s76, 81920, s76
  v_add_u32 v4, s76, v2
  v_mfma_f32_16x16x32_bf16 v[180:183], v[80:83], v[76:79], v[180:183]
  ds_read_b128 v[80:83], v3 offset:0
  v_mfma_f32_16x16x32_bf16 v[184:187], v[84:87], v[72:75], v[184:187]
  s_add_u32 s65, s74, 3
  s_cmp_ge_u32 s65, s82
  s_cbranch_scc1 L_at_mask_e
L_at_maskret_e:
  v_mfma_f32_16x16x32_bf16 v[188:191], v[84:87], v[76:79], v[188:191]
  ds_read_b128 v[84:87], v3 offset:1024
  v_max3_f32 v7, v144, v145, v146
  v_mfma_f32_16x16x32_bf16 v[192:195], v[88:91], v[72:75], v[192:195]
  v_max3_f32 v7, v7, v147, v148
  v_max3_f32 v7, v7, v149, v150
  v_mfma_f32_16x16x32_bf16 v[196:199], v[88:91], v[76:79], v[196:199]
  ds_read_b128 v[88:91], v3 offset:2048
  v_max3_f32 v7, v7, v151, v152
  v_mfma_f32_16x16x32_bf16 v[200:203], v[92:95], v[72:75], v[200:203]
  v_max3_f32 v7, v7, v153, v154
  v_max3_f32 v7, v7, v155, v156
  v_mfma_f32_16x16x32_bf16 v[204:207], v[92:95], v[76:79], v[204:207]
  ds_read_b128 v[92:95], v3 offset:3072
  v_max3_f32 v7, v7, v157, v158
  s_waitcnt lgkmcnt(4)
  v_mfma_f32_16x16x32_bf16 v[208:211], v[96:99], v[72:75], v[208:211]
  v_max3_f32 v7, v7, v159, v160
  v_max3_f32 v7, v7, v161, v162
  v_mfma_f32_16x16x32_bf16 v[212:215], v[96:99], v[76:79], v[212:215]
  ds_read_b128 v[96:99], v3 offset:4096
  v_max3_f32 v7, v7, v163, v164
  v_mfma_f32_16x16x32_bf16 v[216:219], v[100:103], v[72:75], v[216:219]
  v_max3_f32 v7, v7, v165, v166
  v_max3_f32 v7, v7, v167, v168
  v_mfma_f32_16x16x32_bf16 v[220:223], v[100:103], v[76:79], v[220:223]
  ds_read_b128 v[100:103], v3 offset:5120
  v_max3_f32 v7, v7, v169, v170
  v_mfma_f32_16x16x32_bf16 v[224:227], v[104:107], v[72:75], v[224:227]
  v_max3_f32 v7, v7, v171, v172
  v_max3_f32 v7, v7, v173, v174
  v_mfma_f32_16x16x32_bf16 v[228:231], v[104:107], v[76:79], v[228:231]
  ds_read_b128 v[104:107], v3 offset:6144
  v_max_f32 v7, v7, v175
  v_mfma_f32_16x16x32_bf16 v[232:235], v[108:111], v[72:75], v[232:235]
  v_cmp_lt_f32 vcc, 0x41000000, v7
  v_mfma_f32_16x16x32_bf16 v[236:239], v[108:111], v[76:79], v[236:239]
  ds_read_b128 v[108:111], v3 offset:7168
  s_add_u32 s74, s74, 1
  s_cbranch_vccnz L_at_resc_e
L_at_rescret_e:
  s_add_u32 s65, s74, 1
  s_cmp_ge_u32 s65, s82
  s_cbranch_scc1 L_at_final
  s_waitcnt lgkmcnt(4)
  v_mfma_f32_16x16x32_bf16 v[112:115], v[80:83], v[32:35], v[16:19]
  v_exp_f32 v24, v144
  v_mfma_f32_16x16x32_bf16 v[116:119], v[80:83], v[48:51], v[20:23]
  ds_read_b128 v[80:83], v3 offset:8192
  v_exp_f32 v25, v145
  v_mfma_f32_16x16x32_bf16 v[112:115], v[84:87], v[36:39], v[112:115]
  v_exp_f32 v26, v146
  v_exp_f32 v27, v147
  v_mfma_f32_16x16x32_bf16 v[116:119], v[84:87], v[52:55], v[116:119]
  ds_read_b128 v[84:87], v3 offset:9216
  v_add_f32 v9, v9, v24
  v_cvt_pk_bf16_f32 v64, v24, v25
  v_mfma_f32_16x16x32_bf16 v[112:115], v[88:91], v[40:43], v[112:115]
  v_add_f32 v9, v9, v25
  v_exp_f32 v28, v148
  v_mfma_f32_16x16x32_bf16 v[116:119], v[88:91], v[56:59], v[116:119]
  ds_read_b128 v[88:91], v3 offset:10240
  v_exp_f32 v29, v149
  v_mfma_f32_16x16x32_bf16 v[112:115], v[92:95], v[44:47], v[112:115]
  v_add_f32 v9, v9, v26
  v_cvt_pk_bf16_f32 v65, v26, v27
  v_mfma_f32_16x16x32_bf16 v[116:119], v[92:95], v[60:63], v[116:119]
  ds_read_b128 v[92:95], v3 offset:11264
  v_add_f32 v9, v9, v27
  v_exp_f32 v30, v150
  s_waitcnt lgkmcnt(4)
  v_mfma_f32_16x16x32_bf16 v[120:123], v[96:99], v[32:35], v[16:19]
  v_exp_f32 v31, v151
  v_mfma_f32_16x16x32_bf16 v[124:127], v[96:99], v[48:51], v[20:23]
  ds_read_b128 v[96:99], v3 offset:12288
  v_add_f32 v10, v10, v28
  v_cvt_pk_bf16_f32 v68, v28, v29
  v_add_f32 v10, v10, v29
  v_mfma_f32_16x16x32_bf16 v[120:123], v[100:103], v[36:39], v[120:123]
  v_exp_f32 v24, v152
  v_mfma_f32_16x16x32_bf16 v[124:127], v[100:103], v[52:55], v[124:127]
  ds_read_b128 v[100:103], v3 offset:13312
  v_exp_f32 v25, v153
  v_add_f32 v10, v10, v30
  v_mfma_f32_16x16x32_bf16 v[120:123], v[104:107], v[40:43], v[120:123]
  v_cvt_pk_bf16_f32 v69, v30, v31
  v_add_f32 v10, v10, v31
  v_mfma_f32_16x16x32_bf16 v[124:127], v[104:107], v[56:59], v[124:127]
  ds_read_b128 v[104:107], v3 offset:14336
  v_exp_f32 v26, v154
  v_mfma_f32_16x16x32_bf16 v[120:123], v[108:111], v[44:47], v[120:123]
  v_exp_f32 v27, v155
  v_add_f32 v9, v9, v24
  v_mfma_f32_16x16x32_bf16 v[124:127], v[108:111], v[60:63], v[124:127]
  ds_read_b128 v[108:111], v3 offset:15360
  v_cvt_pk_bf16_f32 v66, v24, v25
  v_add_f32 v9, v9, v25
  s_waitcnt lgkmcnt(4)
  v_mfma_f32_16x16x32_bf16 v[128:131], v[80:83], v[32:35], v[16:19]
  v_exp_f32 v28, v156
  v_exp_f32 v29, v157
  v_mfma_f32_16x16x32_bf16 v[132:135], v[80:83], v[48:51], v[20:23]
  ds_read_b128 v[80:83], v4 offset:0
  v_add_f32 v9, v9, v26
  v_cvt_pk_bf16_f32 v67, v26, v27
  v_mfma_f32_16x16x32_bf16 v[128:131], v[84:87], v[36:39], v[128:131]
  v_add_f32 v9, v9, v27
  v_exp_f32 v30, v158
  v_mfma_f32_16x16x32_bf16 v[132:135], v[84:87], v[52:55], v[132:135]
  ds_read_b128 v[84:87], v4 offset:1024
  v_exp_f32 v31, v159
  v_mfma_f32_16x16x32_bf16 v[128:131], v[88:91], v[40:43], v[128:131]
  v_add_f32 v10, v10, v28
  v_cvt_pk_bf16_f32 v70, v28, v29
  v_mfma_f32_16x16x32_bf16 v[132:135], v[88:91], v[56:59], v[132:135]
  ds_read_b128 v[88:91], v4 offset:2048
  v_add_f32 v10, v10, v29
  v_exp_f32 v24, v160
  v_mfma_f32_16x16x32_bf16 v[128:131], v[92:95], v[44:47], v[128:131]
  v_exp_f32 v25, v161
  v_mfma_f32_16x16x32_bf16 v[132:135], v[92:95], v[60:63], v[132:135]
  ds_read_b128 v[92:95], v4 offset:3072
  v_add_f32 v10, v10, v30
  v_cvt_pk_bf16_f32 v71, v30, v31
  v_add_f32 v10, v10, v31
  s_waitcnt lgkmcnt(4)
  v_mfma_f32_16x16x32_bf16 v[136:139], v[96:99], v[32:35], v[16:19]
  v_exp_f32 v26, v162
  v_mfma_f32_16x16x32_bf16 v[140:143], v[96:99], v[48:51], v[20:23]
  ds_read_b128 v[96:99], v4 offset:4096
  v_exp_f32 v27, v163
  v_add_f32 v9, v9, v24
  v_mfma_f32_16x16x32_bf16 v[136:139], v[100:103], v[36:39], v[136:139]
  v_cvt_pk_bf16_f32 v72, v24, v25
  v_add_f32 v9, v9, v25
  v_mfma_f32_16x16x32_bf16 v[140:143], v[100:103], v[52:55], v[140:143]
  ds_read_b128 v[100:103], v4 offset:5120
  v_exp_f32 v28, v164
  v_mfma_f32_16x16x32_bf16 v[136:139], v[104:107], v[40:43], v[136:139]
  v_exp_f32 v29, v165
  v_add_f32 v9, v9, v26
  v_mfma_f32_16x16x32_bf16 v[140:143], v[104:107], v[56:59], v[140:143]
  ds_read_b128 v[104:107], v4 offset:6144
  v_cvt_pk_bf16_f32 v73, v26, v27
  v_add_f32 v9, v9, v27
  v_mfma_f32_16x16x32_bf16 v[136:139], v[108:111], v[44:47], v[136:139]
  v_exp_f32 v30, v166
  v_exp_f32 v31, v167
  v_mfma_f32_16x16x32_bf16 v[140:143], v[108:111], v[60:63], v[140:143]
  ds_read_b128 v[108:111], v4 offset:7168
  v_add_f32 v10, v10, v28
  v_cvt_pk_bf16_f32 v76, v28, v29
  s_waitcnt lgkmcnt(4)
  v_mfma_f32_16x16x32_bf16 v[176:179], v[80:83], v[64:67], v[176:179]
  v_add_f32 v10, v10, v29
  v_exp_f32 v24, v168
  v_mfma_f32_16x16x32_bf16 v[180:183], v[80:83], v[68:71], v[180:183]
  ds_read_b128 v[80:83], v4 offset:8192
  v_exp_f32 v25, v169
  v_mfma_f32_16x16x32_bf16 v[184:187], v[84:87], v[64:67], v[184:187]
  v_add_f32 v10, v10, v30
  v_cvt_pk_bf16_f32 v77, v30, v31
  v_mfma_f32_16x16x32_bf16 v[188:191], v[84:87], v[68:71], v[188:191]
  ds_read_b128 v[84:87], v4 offset:9216
  v_add_f32 v10, v10, v31
  v_exp_f32 v26, v170
  v_mfma_f32_16x16x32_bf16 v[192:195], v[88:91], v[64:67], v[192:195]
  v_exp_f32 v27, v171
  v_mfma_f32_16x16x32_bf16 v[196:199], v[88:91], v[68:71], v[196:199]
  ds_read_b128 v[88:91], v4 offset:10240
  v_add_f32 v9, v9, v24
  v_cvt_pk_bf16_f32 v74, v24, v25
  v_add_f32 v9, v9, v25
  v_mfma_f32_16x16x32_bf16 v[200:203], v[92:95], v[64:67], v[200:203]
  v_exp_f32 v28, v172
  v_mfma_f32_16x16x32_bf16 v[204:207], v[92:95], v[68:71], v[204:207]
  ds_read_b128 v[92:95], v4 offset:11264
  v_exp_f32 v29, v173
  v_add_f32 v9, v9, v26
  s_waitcnt lgkmcnt(4)
  v_mfma_f32_16x16x32_bf16 v[208:211], v[96:99], v[64:67], v[208:211]
  v_cvt_pk_bf16_f32 v75, v26, v27
  v_add_f32 v9, v9, v27
  v_mfma_f32_16x16x32_bf16 v[212:215], v[96:99], v[68:71], v[212:215]
  ds_read_b128 v[96:99], v4 offset:12288
  v_exp_f32 v30, v174
  v_mfma_f32_16x16x32_bf16 v[216:219], v[100:103], v[64:67], v[216:219]
  v_exp_f32 v31, v175
  v_add_f32 v10, v10, v28
  v_mfma_f32_16x16x32_bf16 v[220:223], v[100:103], v[68:71], v[220:223]
  ds_read_b128 v[100:103], v4 offset:13312
  v_cvt_pk_bf16_f32 v78, v28, v29
  v_add_f32 v10, v10, v29
  v_add_f32 v10, v10, v30
  v_mfma_f32_16x16x32_bf16 v[224:227], v[104:107], v[64:67], v[224:227]
  v_cvt_pk_bf16_f32 v79, v30, v31
  v_add_f32 v10, v10, v31
  v_mfma_f32_16x16x32_bf16 v[228:231], v[104:107], v[68:71], v[228:231]
  ds_read_b128 v[104:107], v4 offset:14336
  v_mfma_f32_16x16x32_bf16 v[232:235], v[108:111], v[64:67], v[232:235]
  s_add_u32 s75, s75, 16384
  s_cmp_ge_u32 s75, 81920
  s_cselect_b32 s75, 0, s75
  v_add_u32 v3, s75, v2
  v_mfma_f32_16x16x32_bf16 v[236:239], v[108:111], v[68:71], v[236:239]
  ds_read_b128 v[108:111], v4 offset:15360
  s_waitcnt lgkmcnt(4)
  v_mfma_f32_16x16x32_bf16 v[176:179], v[80:83], v[72:75], v[176:179]
  s_add_u32 s76, s76, 16384
  s_cmp_ge_u32 s76, 163840
  s_cselect_b32 s76, 81920, s76
  v_add_u32 v4, s76, v2
  v_mfma_f32_16x16x32_bf16 v[180:183], v[80:83], v[76:79], v[180:183]
  ds_read_b128 v[80:83], v3 offset:0
  v_mfma_f32_16x16x32_bf16 v[184:187], v[84:87], v[72:75], v[184:187]
  s_add_u32 s65, s74, 3
  s_cmp_ge_u32 s65, s82
  s_cbranch_scc1 L_at_mask_o
L_at_maskret_o:
  v_mfma_f32_16x16x32_bf16 v[188:191], v[84:87], v[76:79], v[188:191]
  ds_read_b128 v[84:87], v3 offset:1024
  v_max3_f32 v7, v112, v113, v114
  v_mfma_f32_16x16x32_bf16 v[192:195], v[88:91], v[72:75], v[192:195]
  v_max3_f32 v7, v7, v115, v116
  v_max3_f32 v7, v7, v117, v118
  v_mfma_f32_16x16x32_bf16 v[196:199], v[88:91], v[76:79], v[196:199]
  ds_read_b128 v[88:91], v3 offset:2048
  v_max3_f32 v7, v7, v119, v120
  v_mfma_f32_16x16x32_bf16 v[200:203], v[92:95], v[72:75], v[200:203]
  v_max3_f32 v7, v7, v121, v122
  v_max3_f32 v7, v7, v123, v124
  v_mfma_f32_16x16x32_bf16 v[204:207], v[92:95], v[76:79], v[204:207]
  ds_read_b128 v[92:95], v3 offset:3072
  v_max3_f32 v7, v7, v125, v126
  s_waitcnt lgkmcnt(4)
  v_mfma_f32_16x16x32_bf16 v[208:211], v[96:99], v[72:75], v[208:211]
  v_max3_f32 v7, v7, v127, v128
  v_max3_f32 v7, v7, v129, v130
  v_mfma_f32_16x16x32_bf16 v[212:215], v[96:99], v[76:79], v[212:215]
  ds_read_b128 v[96:99], v3 offset:4096
  v_max3_f32 v7, v7, v131, v132
  v_mfma_f32_16x16x32_bf16 v[216:219], v[100:103], v[72:75], v[216:219]
  v_max3_f32 v7, v7, v133, v134
  v_max3_f32 v7, v7, v135, v136
  v_mfma_f32_16x16x32_bf16 v[220:223], v[100:103], v[76:79], v[220:223]
  ds_read_b128 v[100:103], v3 offset:5120
  v_max3_f32 v7, v7, v137, v138
  v_mfma_f32_16x16x32_bf16 v[224:227], v[104:107], v[72:75], v[224:227]
  v_max3_f32 v7, v7, v139, v140
  v_max3_f32 v7, v7, v141, v142
  v_mfma_f32_16x16x32_bf16 v[228:231], v[104:107], v[76:79], v[228:231]
  ds_read_b128 v[104:107], v3 offset:6144
  v_max_f32 v7, v7, v143
  v_mfma_f32_16x16x32_bf16 v[232:235], v[108:111], v[72:75], v[232:235]
  v_cmp_lt_f32 vcc, 0x41000000, v7
  v_mfma_f32_16x16x32_bf16 v[236:239], v[108:111], v[76:79], v[236:239]
  ds_read_b128 v[108:111], v3 offset:7168
  s_add_u32 s74, s74, 1
  s_cbranch_vccnz L_at_resc_o
L_at_rescret_o:
  s_branch L_at_loop
L_at_final:
  s_waitcnt lgkmcnt(0)
  ds_read_b128 v[80:83], v4 offset:0
  ds_read_b128 v[84:87], v4 offset:1024
  ds_read_b128 v[88:91], v4 offset:2048
  ds_read_b128 v[92:95], v4 offset:3072
  ds_read_b128 v[96:99], v4 offset:4096
  ds_read_b128 v[100:103], v4 offset:5120
  ds_read_b128 v[104:107], v4 offset:6144
  ds_read_b128 v[108:111], v4 offset:7168
  v_exp_f32 v24, v144
  v_exp_f32 v25, v145
  v_exp_f32 v26, v146
  v_exp_f32 v27, v147
  v_add_f32 v9, v9, v24
  v_cvt_pk_bf16_f32 v64, v24, v25
  v_add_f32 v9, v9, v25
  v_exp_f32 v28, v148
  v_exp_f32 v29, v149
  v_add_f32 v9, v9, v26
  v_cvt_pk_bf16_f32 v65, v26, v27
  v_add_f32 v9, v9, v27
  v_exp_f32 v30, v150
  v_exp_f32 v31, v151
  v_add_f32 v10, v10, v28
  v_cvt_pk_bf16_f32 v68, v28, v29
  v_add_f32 v10, v10, v29
  v_exp_f32 v24, v152
  v_exp_f32 v25, v153
  v_add_f32 v10, v10, v30
  v_cvt_pk_bf16_f32 v69, v30, v31
  v_add_f32 v10, v10, v31
  v_exp_f32 v26, v154
  v_exp_f32 v27, v155
  v_add_f32 v9, v9, v24
  v_cvt_pk_bf16_f32 v66, v24, v25
  v_add_f32 v9, v9, v25
  v_exp_f32 v28, v156
  v_exp_f32 v29, v157
  v_add_f32 v9, v9, v26
  v_cvt_pk_bf16_f32 v67, v26, v27
  v_add_f32 v9, v9, v27
  v_exp_f32 v30, v158
  v_exp_f32 v31, v159
  v_add_f32 v10, v10, v28
  v_cvt_pk_bf16_f32 v70, v28, v29
  v_add_f32 v10, v10, v29
  v_exp_f32 v24, v160
  v_exp_f32 v25, v161
  v_add_f32 v10, v10, v30
  v_cvt_pk_bf16_f32 v71, v30, v31
  v_add_f32 v10, v10, v31
  s_nop 0
  s_waitcnt lgkmcnt(4)
  v_mfma_f32_16x16x32_bf16 v[176:179], v[80:83], v[64:67], v[176:179]
  v_exp_f32 v26, v162
  v_exp_f32 v27, v163
  v_add_f32 v9, v9, v24
  v_mfma_f32_16x16x32_bf16 v[180:183], v[80:83], v[68:71], v[180:183]
  v_cvt_pk_bf16_f32 v72, v24, v25
  v_add_f32 v9, v9, v25
  v_exp_f32 v28, v164
  ds_read_b128 v[80:83], v4 offset:8192
  v_mfma_f32_16x16x32_bf16 v[184:187], v[84:87], v[64:67], v[184:187]
  v_exp_f32 v29, v165
  v_add_f32 v9, v9, v26
  v_cvt_pk_bf16_f32 v73, v26, v27
  v_mfma_f32_16x16x32_bf16 v[188:191], v[84:87], v[68:71], v[188:191]
  v_add_f32 v9, v9, v27
  v_exp_f32 v30, v166
  v_exp_f32 v31, v167
  ds_read_b128 v[84:87], v4 offset:9216
  v_mfma_f32_16x16x32_bf16 v[192:195], v[88:91], v[64:67], v[192:195]
  v_add_f32 v10, v10, v28
  v_cvt_pk_bf16_f32 v76, v28, v29
  v_add_f32 v10, v10, v29
  v_mfma_f32_16x16x32_bf16 v[196:199], v[88:91], v[68:71], v[196:199]
  v_exp_f32 v24, v168
  v_exp_f32 v25, v169
  v_add_f32 v10, v10, v30
  ds_read_b128 v[88:91], v4 offset:10240
  v_mfma_f32_16x16x32_bf16 v[200:203], v[92:95], v[64:67], v[200:203]
  v_cvt_pk_bf16_f32 v77, v30, v31
  v_add_f32 v10, v10, v31
  v_exp_f32 v26, v170
  v_mfma_f32_16x16x32_bf16 v[204:207], v[92:95], v[68:71], v[204:207]
  v_exp_f32 v27, v171
  v_add_f32 v9, v9, v24
  v_cvt_pk_bf16_f32 v74, v24, v25
  ds_read_b128 v[92:95], v4 offset:11264
  s_waitcnt lgkmcnt(4)
  v_mfma_f32_16x16x32_bf16 v[208:211], v[96:99], v[64:67], v[208:211]
  v_add_f32 v9, v9, v25
  v_exp_f32 v28, v172
  v_exp_f32 v29, v173
  v_mfma_f32_16x16x32_bf16 v[212:215], v[96:99], v[68:71], v[212:215]
  v_add_f32 v9, v9, v26
  v_cvt_pk_bf16_f32 v75, v26, v27
  v_add_f32 v9, v9, v27
  ds_read_b128 v[96:99], v4 offset:12288
  v_mfma_f32_16x16x32_bf16 v[216:219], v[100:103], v[64:67], v[216:219]
  v_exp_f32 v30, v174
  v_exp_f32 v31, v175
  v_add_f32 v10, v10, v28
  v_mfma_f32_16x16x32_bf16 v[220:223], v[100:103], v[68:71], v[220:223]
  v_cvt_pk_bf16_f32 v78, v28, v29
  v_add_f32 v10, v10, v29
  v_add_f32 v10, v10, v30
  ds_read_b128 v[100:103], v4 offset:13312
  v_mfma_f32_16x16x32_bf16 v[224:227], v[104:107], v[64:67], v[224:227]
  v_cvt_pk_bf16_f32 v79, v30, v31
  v_add_f32 v10, v10, v31
  v_mfma_f32_16x16x32_bf16 v[228:231], v[104:107], v[68:71], v[228:231]
  ds_read_b128 v[104:107], v4 offset:14336
  v_mfma_f32_16x16x32_bf16 v[232:235], v[108:111], v[64:67], v[232:235]
  v_mfma_f32_16x16x32_bf16 v[236:239], v[108:111], v[68:71], v[236:239]
  ds_read_b128 v[108:111], v4 offset:15360
  s_nop 0
  s_waitcnt lgkmcnt(4)
  v_mfma_f32_16x16x32_bf16 v[176:179], v[80:83], v[72:75], v[176:179]
  v_mfma_f32_16x16x32_bf16 v[180:183], v[80:83], v[76:79], v[180:183]
  v_mfma_f32_16x16x32_bf16 v[184:187], v[84:87], v[72:75], v[184:187]
  v_mfma_f32_16x16x32_bf16 v[188:191], v[84:87], v[76:79], v[188:191]
  v_mfma_f32_16x16x32_bf16 v[192:195], v[88:91], v[72:75], v[192:195]
  v_mfma_f32_16x16x32_bf16 v[196:199], v[88:91], v[76:79], v[196:199]
  v_mfma_f32_16x16x32_bf16 v[200:203], v[92:95], v[72:75], v[200:203]
  v_mfma_f32_16x16x32_bf16 v[204:207], v[92:95], v[76:79], v[204:207]
  s_waitcnt lgkmcnt(0)
  v_mfma_f32_16x16x32_bf16 v[208:211], v[96:99], v[72:75], v[208:211]
  v_mfma_f32_16x16x32_bf16 v[212:215], v[96:99], v[76:79], v[212:215]
  v_mfma_f32_16x16x32_bf16 v[216:219], v[100:103], v[72:75], v[216:219]
  v_mfma_f32_16x16x32_bf16 v[220:223], v[100:103], v[76:79], v[220:223]
  v_mfma_f32_16x16x32_bf16 v[224:227], v[104:107], v[72:75], v[224:227]
  v_mfma_f32_16x16x32_bf16 v[228:231], v[104:107], v[76:79], v[228:231]
  v_mfma_f32_16x16x32_bf16 v[232:235], v[108:111], v[72:75], v[232:235]
  v_mfma_f32_16x16x32_bf16 v[236:239], v[108:111], v[76:79], v[236:239]
  s_add_u32 s74, s74, 1
  v_mov_b32 v247, v9
  s_nop 1
  v_permlane16_swap_b32 v9, v247
  v_add_f32 v9, v9, v247
  v_mov_b32 v247, v9
  s_nop 1
  v_permlane32_swap_b32 v9, v247
  v_add_f32 v9, v9, v247
  v_rcp_f32 v9, v9
  v_mov_b32 v247, v10
  s_nop 1
  v_permlane16_swap_b32 v10, v247
  v_add_f32 v10, v10, v247
  v_mov_b32 v247, v10
  s_nop 1
  v_permlane32_swap_b32 v10, v247
  v_add_f32 v10, v10, v247
  v_rcp_f32 v10, v10
  s_lshl_b32 s65, s83, 6
  s_add_u32 s65, s65, s60
  s_lshl_b32 s65, s65, 12
  s_add_u32 s65, s65, 35651584
  s_add_u32 s66, s65, 131072
  s_nop 3
  v_mul_f32 v176, v176, v9
  v_mul_f32 v177, v177, v9
  v_mul_f32 v178, v178, v9
  v_mul_f32 v179, v179, v9
  v_mul_f32 v184, v184, v9
  v_mul_f32 v185, v185, v9
  v_mul_f32 v186, v186, v9
  v_mul_f32 v187, v187, v9
  v_cvt_pk_bf16_f32 v112, v176, v177
  v_cvt_pk_bf16_f32 v113, v178, v179
  v_cvt_pk_bf16_f32 v114, v184, v185
  v_cvt_pk_bf16_f32 v115, v186, v187
  buffer_store_dwordx4 v[112:115], v2, s[56:59], s65 offen offset:0 sc1
  v_mul_f32 v192, v192, v9
  v_mul_f32 v193, v193, v9
  v_mul_f32 v194, v194, v9
  v_mul_f32 v195, v195, v9
  v_mul_f32 v200, v200, v9
  v_mul_f32 v201, v201, v9
  v_mul_f32 v202, v202, v9
  v_mul_f32 v203, v203, v9
  v_cvt_pk_bf16_f32 v116, v192, v193
  v_cvt_pk_bf16_f32 v117, v194, v195
  v_cvt_pk_bf16_f32 v118, v200, v201
  v_cvt_pk_bf16_f32 v119, v202, v203
  buffer_store_dwordx4 v[116:119], v2, s[56:59], s65 offen offset:1024 sc1
  v_mul_f32 v208, v208, v9
  v_mul_f32 v209, v209, v9
  v_mul_f32 v210, v210, v9
  v_mul_f32 v211, v211, v9
  v_mul_f32 v216, v216, v9
  v_mul_f32 v217, v217, v9
  v_mul_f32 v218, v218, v9
  v_mul_f32 v219, v219, v9
  v_cvt_pk_bf16_f32 v120, v208, v209
  v_cvt_pk_bf16_f32 v121, v210, v211
  v_cvt_pk_bf16_f32 v122, v216, v217
  v_cvt_pk_bf16_f32 v123, v218, v219
  buffer_store_dwordx4 v[120:123], v2, s[56:59], s65 offen offset:2048 sc1
  v_mul_f32 v224, v224, v9
  v_mul_f32 v225, v225, v9
  v_mul_f32 v226, v226, v9
  v_mul_f32 v227, v227, v9
  v_mul_f32 v232, v232, v9
  v_mul_f32 v233, v233, v9
  v_mul_f32 v234, v234, v9
  v_mul_f32 v235, v235, v9
  v_cvt_pk_bf16_f32 v124, v224, v225
  v_cvt_pk_bf16_f32 v125, v226, v227
  v_cvt_pk_bf16_f32 v126, v232, v233
  v_cvt_pk_bf16_f32 v127, v234, v235
  buffer_store_dwordx4 v[124:127], v2, s[56:59], s65 offen offset:3072 sc1
  v_mul_f32 v180, v180, v10
  v_mul_f32 v181, v181, v10
  v_mul_f32 v182, v182, v10
  v_mul_f32 v183, v183, v10
  v_mul_f32 v188, v188, v10
  v_mul_f32 v189, v189, v10
  v_mul_f32 v190, v190, v10
  v_mul_f32 v191, v191, v10
  v_cvt_pk_bf16_f32 v128, v180, v181
  v_cvt_pk_bf16_f32 v129, v182, v183
  v_cvt_pk_bf16_f32 v130, v188, v189
  v_cvt_pk_bf16_f32 v131, v190, v191
  buffer_store_dwordx4 v[128:131], v2, s[56:59], s66 offen offset:0 sc1
  v_mul_f32 v196, v196, v10
  v_mul_f32 v197, v197, v10
  v_mul_f32 v198, v198, v10
  v_mul_f32 v199, v199, v10
  v_mul_f32 v204, v204, v10
  v_mul_f32 v205, v205, v10
  v_mul_f32 v206, v206, v10
  v_mul_f32 v207, v207, v10
  v_cvt_pk_bf16_f32 v132, v196, v197
  v_cvt_pk_bf16_f32 v133, v198, v199
  v_cvt_pk_bf16_f32 v134, v204, v205
  v_cvt_pk_bf16_f32 v135, v206, v207
  buffer_store_dwordx4 v[132:135], v2, s[56:59], s66 offen offset:1024 sc1
  v_mul_f32 v212, v212, v10
  v_mul_f32 v213, v213, v10
  v_mul_f32 v214, v214, v10
  v_mul_f32 v215, v215, v10
  v_mul_f32 v220, v220, v10
  v_mul_f32 v221, v221, v10
  v_mul_f32 v222, v222, v10
  v_mul_f32 v223, v223, v10
  v_cvt_pk_bf16_f32 v136, v212, v213
  v_cvt_pk_bf16_f32 v137, v214, v215
  v_cvt_pk_bf16_f32 v138, v220, v221
  v_cvt_pk_bf16_f32 v139, v222, v223
  buffer_store_dwordx4 v[136:139], v2, s[56:59], s66 offen offset:2048 sc1
  v_mul_f32 v228, v228, v10
  v_mul_f32 v229, v229, v10
  v_mul_f32 v230, v230, v10
  v_mul_f32 v231, v231, v10
  v_mul_f32 v236, v236, v10
  v_mul_f32 v237, v237, v10
  v_mul_f32 v238, v238, v10
  v_mul_f32 v239, v239, v10
  v_cvt_pk_bf16_f32 v140, v228, v229
  v_cvt_pk_bf16_f32 v141, v230, v231
  v_cvt_pk_bf16_f32 v142, v236, v237
  v_cvt_pk_bf16_f32 v143, v238, v239
  buffer_store_dwordx4 v[140:143], v2, s[56:59], s66 offen offset:3072 sc1
  s_cmp_eq_u32 s63, 0
  s_cbranch_scc1 L_at_end
L_at_ldloop:
  s_cmp_ge_u32 s74, s81
  s_cbranch_scc1 L_at_end
  s_waitcnt vmcnt(4)
  s_barrier
  s_add_u32 m0, s72, 0
  s_add_u32 s72, s72, 16384
  buffer_load_dwordx4 v2, s[44:47], s68 offen offset:0 sc1 lds
  buffer_load_dwordx4 v2, s[44:47], s68 offen offset:1024 sc1 lds
  buffer_load_dwordx4 v2, s[44:47], s68 offen offset:2048 sc1 lds
  buffer_load_dwordx4 v2, s[44:47], s68 offen offset:3072 sc1 lds
  s_cmp_ge_u32 s72, 81920
  s_cselect_b32 s65, 81920, 0
  s_sub_u32 s72, s72, s65
  s_add_u32 s68, s68, 16384
  s_add_u32 m0, s72, 0
  s_add_u32 s72, s72, 16384
  buffer_load_dwordx4 v2, s[44:47], s68 offen offset:0 sc1 lds
  buffer_load_dwordx4 v2, s[44:47], s68 offen offset:1024 sc1 lds
  buffer_load_dwordx4 v2, s[44:47], s68 offen offset:2048 sc1 lds
  buffer_load_dwordx4 v2, s[44:47], s68 offen offset:3072 sc1 lds
  s_cmp_ge_u32 s72, 81920
  s_cselect_b32 s65, 81920, 0
  s_sub_u32 s72, s72, s65
  s_add_u32 s68, s68, 16384
  s_add_u32 m0, s73, 81920
  s_add_u32 s73, s73, 16384
  buffer_load_dwordx4 v2, s[52:55], s69 offen offset:0 sc1 lds
  buffer_load_dwordx4 v2, s[52:55], s69 offen offset:1024 sc1 lds
  buffer_load_dwordx4 v2, s[52:55], s69 offen offset:2048 sc1 lds
  buffer_load_dwordx4 v2, s[52:55], s69 offen offset:3072 sc1 lds
  s_cmp_ge_u32 s73, 81920
  s_cselect_b32 s65, 81920, 0
  s_sub_u32 s73, s73, s65
  s_add_u32 s69, s69, 16384
  s_add_u32 m0, s73, 81920
  s_add_u32 s73, s73, 16384
  buffer_load_dwordx4 v2, s[52:55], s69 offen offset:0 sc1 lds
  buffer_load_dwordx4 v2, s[52:55], s69 offen offset:1024 sc1 lds
  buffer_load_dwordx4 v2, s[52:55], s69 offen offset:2048 sc1 lds
  buffer_load_dwordx4 v2, s[52:55], s69 offen offset:3072 sc1 lds
  s_cmp_ge_u32 s73, 81920
  s_cselect_b32 s65, 81920, 0
  s_sub_u32 s73, s73, s65
  s_add_u32 s69, s69, 16384
  s_add_u32 s74, s74, 2
  s_branch L_at_ldloop
L_at_end:
  s_waitcnt vmcnt(0) lgkmcnt(0)
  s_barrier
  s_cmp_lg_u32 s3, 4
  s_cbranch_scc1 L_pub_19
  s_lshl_b32 s65, s61, 8
  s_add_u32 s65, s65, s60
  s_add_u32 s65, s65, 100794368
  s_sub_u32 s66, 15, s61
  s_lshl_b32 s66, s66, 8
  s_add_u32 s66, s66, s60
  s_add_u32 s66, s66, 100794368
  s_mov_b64 exec, 1
  v_mov_b32 v0, 1
  buffer_store_byte v0, off, s[56:59], s65 sc1
  buffer_store_byte v0, off, s[56:59], s66 sc1
  s_mov_b64 exec, -1
L_pub_19:
  s_load_dwordx16 s[16:31], s[0:1], 0
  s_load_dwordx8 s[32:39], s[0:1], 64
  s_load_dwordx2 s[40:41], s[0:1], 96
  v_lshlrev_b32 v2, 4, v1
  v_lshrrev_b32 v8, 4, v1
  v_and_b32 v9, 15, v1
  v_bfe_u32 v10, v1, 2, 2
  v_and_b32 v11, 3, v1
  s_lshr_b32 s63, s3, 2
  s_and_b32 s64, s3, 3
  s_and_b32 s68, s2, 3
  s_bfe_u32 s65, s2, 0x10002
  s_lshr_b32 s66, s2, 3
  s_and_b32 s70, s66, 3
  s_lshr_b32 s69, s66, 2
  s_mul_i32 s65, s65, 15
  s_xor_b32 s69, s69, s65
  s_and_b32 s66, s3, 1
  s_lshl_b32 s66, s66, 1
  v_xor_b32 v12, s66, v11
  s_lshl_b32 s65, s3, 2
  v_add_u32 v13, s65, v10
  v_lshlrev_b32 v13, 10, v13
  v_lshl_add_u32 v13, v8, 6, v13
  v_lshl_add_u32 v3, v12, 4, v13
  s_lshl_b32 s73, s3, 10
  s_cmp_lt_u32 s68, 3
  s_cselect_b32 s67, 128, 43
  s_cselect_b32 s66, 43, 0
  s_mul_i32 s66, s66, s68
  s_lshl_b32 s71, s69, 3
  s_add_u32 s71, s71, s3
  s_mul_i32 s71, s71, s67
  s_add_u32 s71, s71, s66
  s_lshl_b32 s71, s71, 10
  s_cmp_lt_u32 s68, 3
  s_cselect_b32 s67, 0, 16777216
  s_add_u32 s71, s71, s67
  s_add_u32 s71, s71, 35651584
  s_lshl_b32 s72, s70, 8
  s_waitcnt lgkmcnt(0)
  s_mov_b32 s44, s40
  s_mov_b32 s45, s41
  s_mov_b32 s46, 58064896
  s_mov_b32 s47, 0x00020000
  s_cmp_lt_u32 s68, 3
  s_cselect_b32 s48, s26, s34
  s_cselect_b32 s49, s27, s35
  s_lshl_b32 s66, s66, 15
  s_add_u32 s48, s48, s66
  s_addc_u32 s49, s49, 0
  s_cmp_eq_u32 s68, 2
  s_cselect_b32 s50, 42, 43
  s_lshl_b32 s65, s50, 10
  s_add_u32 s46, s71, s65
  s_lshl_b32 s50, s50, 15
  s_mov_b32 s51, 0x00020000
  s_add_u32 m0, s73, 8192
  s_add_u32 s65, s72, 0
  buffer_load_dwordx4 v3, s[48:51], s65 offen lds
  s_add_u32 m0, s73, 24576
  s_add_u32 s65, s72, 32768
  buffer_load_dwordx4 v3, s[48:51], s65 offen lds
  s_add_u32 m0, s73, 40960
  s_add_u32 s65, s72, 65536
  buffer_load_dwordx4 v3, s[48:51], s65 offen lds
  s_add_u32 m0, s73, 57344
  s_add_u32 s65, s72, 98304
  buffer_load_dwordx4 v3, s[48:51], s65 offen lds
  s_add_u32 m0, s73, 73728
  s_add_u32 s65, s72, 131072
  buffer_load_dwordx4 v3, s[48:51], s65 offen lds
  s_add_u32 m0, s73, 90112
  s_add_u32 s65, s72, 163840
  buffer_load_dwordx4 v3, s[48:51], s65 offen lds
  s_add_u32 m0, s73, 106496
  s_add_u32 s65, s72, 196608
  buffer_load_dwordx4 v3, s[48:51], s65 offen lds
  s_add_u32 m0, s73, 122880
  s_add_u32 s65, s72, 229376
  buffer_load_dwordx4 v3, s[48:51], s65 offen lds
  s_add_u32 s72, s72, 262144
  s_mov_b32 s52, s36
  s_mov_b32 s53, s37
  s_mov_b32 s54, 2097152
  s_mov_b32 s55, 0x00020000
  s_mov_b32 s8, s16
  s_mov_b32 s9, s17
  s_mov_b32 s10, 2097152
  s_mov_b32 s11, 0x00020000
  s_lshl_b32 s65, s63, 12
  v_add_u32 v4, s65, v2
  v_and_b32 v12, 1, v8
  v_lshlrev_b32 v13, 10, v8
  v_lshl_add_u32 v13, v10, 6, v13
  v_lshl_add_u32 v13, v11, 3, v13
  s_lshl_b32 s65, s64, 8
  s_add_u32 s65, s65, 8192
  v_add_u32 v13, s65, v13
  v_lshl_add_u32 v5, v12, 5, v13
  v_xor_b32 v6, 32, v5
  s_lshl_b32 s65, s69, 7
  s_lshl_b32 s66, s63, 6
  s_add_u32 s65, s65, s66
  s_lshl_b32 s66, s68, 4
  s_add_u32 s65, s65, s66
  s_lshl_b32 s65, s65, 10
  s_lshl_b32 s66, s70, 8
  s_add_u32 s65, s65, s66
  s_lshl_b32 s66, s64, 6
  s_add_u32 s65, s65, s66
  v_lshlrev_b32 v7, 10, v9
  v_lshl_add_u32 v7, v8, 3, v7
  v_add_u32 v7, s65, v7
  s_lshl_b32 s75, s69, 2
  s_add_u32 s75, s75, s70
  s_lshl_b32 s75, s75, 17
  s_lshl_b32 s65, s3, 10
  s_add_u32 s75, s75, s65
  s_add_u32 s75, s75, 67108864
  v_mov_b32 v112, 0
  v_mov_b32 v113, 0
  v_mov_b32 v114, 0
  v_mov_b32 v115, 0
  v_mov_b32 v116, 0
  v_mov_b32 v117, 0
  v_mov_b32 v118, 0
  v_mov_b32 v119, 0
  v_mov_b32 v120, 0
  v_mov_b32 v121, 0
  v_mov_b32 v122, 0
  v_mov_b32 v123, 0
  v_mov_b32 v124, 0
  v_mov_b32 v125, 0
  v_mov_b32 v126, 0
  v_mov_b32 v127, 0
  v_mov_b32 v128, 0
  v_mov_b32 v129, 0
  v_mov_b32 v130, 0
  v_mov_b32 v131, 0
  v_mov_b32 v132, 0
  v_mov_b32 v133, 0
  v_mov_b32 v134, 0
  v_mov_b32 v135, 0
  v_mov_b32 v136, 0
  v_mov_b32 v137, 0
  v_mov_b32 v138, 0
  v_mov_b32 v139, 0
  v_mov_b32 v140, 0
  v_mov_b32 v141, 0
  v_mov_b32 v142, 0
  v_mov_b32 v143, 0
  s_cmp_lg_u32 s3, 4
  s_cbranch_scc1 L_o_rdy
  s_lshl_b32 s65, s69, 8
  s_add_u32 s65, s65, 100794368
  v_and_b32 v12, 7, v1
  v_lshlrev_b32 v12, 2, v12
L_o_rp:
  buffer_load_dword v0, v12, s[56:59], s65 offen sc1
  s_waitcnt vmcnt(0)
  v_cmp_ne_u32 vcc, 0x01010101, v0
  s_cbranch_vccz L_o_rdy
  s_sleep 4
  s_branch L_o_rp
L_o_rdy:
  s_barrier
  s_add_u32 m0, s73, 0
  s_add_u32 s65, s71, 0
  buffer_load_dwordx4 v2, s[44:47], s65 offen offset:0 sc1 lds
  s_add_u32 m0, s73, 15360
  s_add_u32 s65, s71, 0
  buffer_load_dwordx4 v2, s[44:47], s65 offen offset:1024 sc1 lds
  s_add_u32 m0, s73, 32768
  s_add_u32 s65, s71, 2048
  buffer_load_dwordx4 v2, s[44:47], s65 offen offset:0 sc1 lds
  s_add_u32 m0, s73, 48128
  s_add_u32 s65, s71, 2048
  buffer_load_dwordx4 v2, s[44:47], s65 offen offset:1024 sc1 lds
  s_add_u32 m0, s73, 65536
  s_add_u32 s65, s71, 4096
  buffer_load_dwordx4 v2, s[44:47], s65 offen offset:0 sc1 lds
  s_add_u32 m0, s73, 80896
  s_add_u32 s65, s71, 4096
  buffer_load_dwordx4 v2, s[44:47], s65 offen offset:1024 sc1 lds
  s_add_u32 m0, s73, 98304
  s_add_u32 s65, s71, 6144
  buffer_load_dwordx4 v2, s[44:47], s65 offen offset:0 sc1 lds
  s_add_u32 m0, s73, 113664
  s_add_u32 s65, s71, 6144
  buffer_load_dwordx4 v2, s[44:47], s65 offen offset:1024 sc1 lds
  s_add_u32 s71, s71, 8192
  s_waitcnt vmcnt(0)
  s_barrier
  ds_read_b64_tr_b16 v[32:33], v5 offset:0
  ds_read_b64_tr_b16 v[34:35], v5 offset:4096
  ds_read_b64_tr_b16 v[36:37], v6 offset:0
  ds_read_b64_tr_b16 v[38:39], v6 offset:4096
  ds_read_b128 v[16:19], v4 offset:0
  ds_read_b128 v[20:23], v4 offset:1024
  ds_read_b128 v[24:27], v4 offset:2048
  ds_read_b128 v[28:31], v4 offset:3072
  ds_read_b64_tr_b16 v[56:57], v5 offset:16384
  ds_read_b64_tr_b16 v[58:59], v5 offset:20480
  ds_read_b64_tr_b16 v[60:61], v6 offset:16384
  ds_read_b64_tr_b16 v[62:63], v6 offset:20480
  ds_read_b128 v[40:43], v4 offset:16384
  ds_read_b128 v[44:47], v4 offset:17408
  ds_read_b128 v[48:51], v4 offset:18432
  ds_read_b128 v[52:55], v4 offset:19456
  v_add_u32 v4, 32768, v4
  v_and_b32 v4, 0x1ffff, v4
  v_add_u32 v5, 32768, v5
  v_and_b32 v5, 0x1ffff, v5
  v_add_u32 v6, 32768, v6
  v_and_b32 v6, 0x1ffff, v6
  s_mov_b32 s74, 0
  s_mov_b64 vcc, 0
L_o_loop:
  s_cbranch_vccnz L_o_w1
  s_waitcnt vmcnt(8) lgkmcnt(0)
L_o_j1:
  s_barrier
  s_cmp_ge_u32 s74, 9
  s_cselect_b64 vcc, -1, 0
  v_mfma_f32_16x16x32_bf16 v[112:115], v[32:35], v[16:19], v[112:115]
  ds_read_b64_tr_b16 v[80:81], v5 offset:0
  v_mfma_f32_16x16x32_bf16 v[116:119], v[36:39], v[16:19], v[116:119]
  ds_read_b64_tr_b16 v[82:83], v5 offset:4096
  s_cbranch_vccnz L_o_s2
  s_add_u32 m0, s73, 0
  s_nop 0
  buffer_load_dwordx4 v2, s[44:47], s71 offen offset:0 sc1 lds
L_o_s2:
  v_mfma_f32_16x16x32_bf16 v[120:123], v[32:35], v[20:23], v[120:123]
  ds_read_b64_tr_b16 v[84:85], v6 offset:0
  v_mfma_f32_16x16x32_bf16 v[124:127], v[36:39], v[20:23], v[124:127]
  ds_read_b64_tr_b16 v[86:87], v6 offset:4096
  v_mfma_f32_16x16x32_bf16 v[128:131], v[32:35], v[24:27], v[128:131]
  ds_read_b128 v[64:67], v4 offset:0
  v_mfma_f32_16x16x32_bf16 v[132:135], v[36:39], v[24:27], v[132:135]
  ds_read_b128 v[68:71], v4 offset:1024
  s_cbranch_vccnz L_o_s3
  s_add_u32 m0, s73, 8192
  s_add_u32 s65, s72, 0
  buffer_load_dwordx4 v3, s[48:51], s65 offen lds
L_o_s3:
  v_mfma_f32_16x16x32_bf16 v[136:139], v[32:35], v[28:31], v[136:139]
  ds_read_b128 v[72:75], v4 offset:2048
  v_mfma_f32_16x16x32_bf16 v[140:143], v[36:39], v[28:31], v[140:143]
  ds_read_b128 v[76:79], v4 offset:3072
  v_mfma_f32_16x16x32_bf16 v[112:115], v[56:59], v[40:43], v[112:115]
  ds_read_b64_tr_b16 v[104:105], v5 offset:16384
  v_mfma_f32_16x16x32_bf16 v[116:119], v[60:63], v[40:43], v[116:119]
  ds_read_b64_tr_b16 v[106:107], v5 offset:20480
  s_cbranch_vccnz L_o_s4
  s_add_u32 m0, s73, 15360
  s_nop 0
  buffer_load_dwordx4 v2, s[44:47], s71 offen offset:1024 sc1 lds
L_o_s4:
  v_mfma_f32_16x16x32_bf16 v[120:123], v[56:59], v[44:47], v[120:123]
  ds_read_b64_tr_b16 v[108:109], v6 offset:16384
  v_mfma_f32_16x16x32_bf16 v[124:127], v[60:63], v[44:47], v[124:127]
  ds_read_b64_tr_b16 v[110:111], v6 offset:20480
  v_mfma_f32_16x16x32_bf16 v[128:131], v[56:59], v[48:51], v[128:131]
  ds_read_b128 v[88:91], v4 offset:16384
  v_mfma_f32_16x16x32_bf16 v[132:135], v[60:63], v[48:51], v[132:135]
  ds_read_b128 v[92:95], v4 offset:17408
  s_cbranch_vccnz L_o_s5
  s_add_u32 m0, s73, 24576
  s_add_u32 s65, s72, 32768
  buffer_load_dwordx4 v3, s[48:51], s65 offen lds
  s_add_u32 s71, s71, 2048
  s_add_u32 s72, s72, 65536
  s_add_u32 s73, s73, 32768
  s_and_b32 s73, s73, 0x1ffff
L_o_s5:
  v_mfma_f32_16x16x32_bf16 v[136:139], v[56:59], v[52:55], v[136:139]
  ds_read_b128 v[96:99], v4 offset:18432
  v_mfma_f32_16x16x32_bf16 v[140:143], v[60:63], v[52:55], v[140:143]
  ds_read_b128 v[100:103], v4 offset:19456
  v_add_u32 v4, 32768, v4
  v_and_b32 v4, 0x1ffff, v4
  v_add_u32 v5, 32768, v5
  v_and_b32 v5, 0x1ffff, v5
  v_add_u32 v6, 32768, v6
  v_and_b32 v6, 0x1ffff, v6
  s_cbranch_vccnz L_o_w6
  s_waitcnt vmcnt(8) lgkmcnt(0)
L_o_j6:
  s_barrier
  v_mfma_f32_16x16x32_bf16 v[112:115], v[80:83], v[64:67], v[112:115]
  ds_read_b64_tr_b16 v[32:33], v5 offset:0
  v_mfma_f32_16x16x32_bf16 v[116:119], v[84:87], v[64:67], v[116:119]
  ds_read_b64_tr_b16 v[34:35], v5 offset:4096
  s_cbranch_vccnz L_o_s7
  s_add_u32 m0, s73, 0
  s_nop 0
  buffer_load_dwordx4 v2, s[44:47], s71 offen offset:0 sc1 lds
L_o_s7:
  v_mfma_f32_16x16x32_bf16 v[120:123], v[80:83], v[68:71], v[120:123]
  ds_read_b64_tr_b16 v[36:37], v6 offset:0
  v_mfma_f32_16x16x32_bf16 v[124:127], v[84:87], v[68:71], v[124:127]
  ds_read_b64_tr_b16 v[38:39], v6 offset:4096
  v_mfma_f32_16x16x32_bf16 v[128:131], v[80:83], v[72:75], v[128:131]
  ds_read_b128 v[16:19], v4 offset:0
  v_mfma_f32_16x16x32_bf16 v[132:135], v[84:87], v[72:75], v[132:135]
  ds_read_b128 v[20:23], v4 offset:1024
  s_cbranch_vccnz L_o_s8
  s_add_u32 m0, s73, 8192
  s_add_u32 s65, s72, 0
  buffer_load_dwordx4 v3, s[48:51], s65 offen lds
L_o_s8:
  v_mfma_f32_16x16x32_bf16 v[136:139], v[80:83], v[76:79], v[136:139]
  ds_read_b128 v[24:27], v4 offset:2048
  v_mfma_f32_16x16x32_bf16 v[140:143], v[84:87], v[76:79], v[140:143]
  ds_read_b128 v[28:31], v4 offset:3072
  v_mfma_f32_16x16x32_bf16 v[112:115], v[104:107], v[88:91], v[112:115]
  ds_read_b64_tr_b16 v[56:57], v5 offset:16384
  v_mfma_f32_16x16x32_bf16 v[116:119], v[108:111], v[88:91], v[116:119]
  ds_read_b64_tr_b16 v[58:59], v5 offset:20480
  s_cbranch_vccnz L_o_s9
  s_add_u32 m0, s73, 15360
  s_nop 0
  buffer_load_dwordx4 v2, s[44:47], s71 offen offset:1024 sc1 lds
L_o_s9:
  v_mfma_f32_16x16x32_bf16 v[120:123], v[104:107], v[92:95], v[120:123]
  ds_read_b64_tr_b16 v[60:61], v6 offset:16384
  v_mfma_f32_16x16x32_bf16 v[124:127], v[108:111], v[92:95], v[124:127]
  ds_read_b64_tr_b16 v[62:63], v6 offset:20480
  v_mfma_f32_16x16x32_bf16 v[128:131], v[104:107], v[96:99], v[128:131]
  ds_read_b128 v[40:43], v4 offset:16384
  v_mfma_f32_16x16x32_bf16 v[132:135], v[108:111], v[96:99], v[132:135]
  ds_read_b128 v[44:47], v4 offset:17408
  s_cbranch_vccnz L_o_s10
  s_add_u32 m0, s73, 24576
  s_add_u32 s65, s72, 32768
  buffer_load_dwordx4 v3, s[48:51], s65 offen lds
  s_add_u32 s71, s71, 2048
  s_add_u32 s72, s72, 65536
  s_add_u32 s73, s73, 32768
  s_and_b32 s73, s73, 0x1ffff
L_o_s10:
  v_mfma_f32_16x16x32_bf16 v[136:139], v[104:107], v[100:103], v[136:139]
  ds_read_b128 v[48:51], v4 offset:18432
  v_mfma_f32_16x16x32_bf16 v[140:143], v[108:111], v[100:103], v[140:143]
  ds_read_b128 v[52:55], v4 offset:19456
  v_add_u32 v4, 32768, v4
  v_and_b32 v4, 0x1ffff, v4
  v_add_u32 v5, 32768, v5
  v_and_b32 v5, 0x1ffff, v5
  v_add_u32 v6, 32768, v6
  v_and_b32 v6, 0x1ffff, v6
  s_add_u32 s74, s74, 1
  s_cmp_lt_u32 s74, 11
  s_cbranch_scc1 L_o_loop
  buffer_load_dwordx2 v[12:13], v7, s[8:11], 0 offen
  buffer_load_dwordx2 v[14:15], v7, s[8:11], 0 offen offset:32
  s_lshl_b32 s66, s68, 15
  s_add_u32 s66, s66, s75
  s_nop 4
  s_cmp_eq_u32 s68, 0
  s_cbranch_scc1 L_o_st0
  s_add_u32 s65, s66, 0
  v_cvt_pk_bf16_f32 v176, v112, v113
  v_cvt_pk_bf16_f32 v177, v114, v115
  v_cvt_pk_bf16_f32 v178, v116, v117
  v_cvt_pk_bf16_f32 v179, v118, v119
  buffer_store_dwordx4 v[176:179], v2, s[56:59], s65 offen sc1
L_o_st0:
  s_cmp_eq_u32 s68, 1
  s_cbranch_scc1 L_o_st1
  s_add_u32 s65, s66, 8192
  v_cvt_pk_bf16_f32 v180, v120, v121
  v_cvt_pk_bf16_f32 v181, v122, v123
  v_cvt_pk_bf16_f32 v182, v124, v125
  v_cvt_pk_bf16_f32 v183, v126, v127
  buffer_store_dwordx4 v[180:183], v2, s[56:59], s65 offen sc1
L_o_st1:
  s_cmp_eq_u32 s68, 2
  s_cbranch_scc1 L_o_st2
  s_add_u32 s65, s66, 16384
  v_cvt_pk_bf16_f32 v184, v128, v129
  v_cvt_pk_bf16_f32 v185, v130, v131
  v_cvt_pk_bf16_f32 v186, v132, v133
  v_cvt_pk_bf16_f32 v187, v134, v135
  buffer_store_dwordx4 v[184:187], v2, s[56:59], s65 offen sc1
L_o_st2:
  s_cmp_eq_u32 s68, 3
  s_cbranch_scc1 L_o_st3
  s_add_u32 s65, s66, 24576
  v_cvt_pk_bf16_f32 v188, v136, v137
  v_cvt_pk_bf16_f32 v189, v138, v139
  v_cvt_pk_bf16_f32 v190, v140, v141
  v_cvt_pk_bf16_f32 v191, v142, v143
  buffer_store_dwordx4 v[188:191], v2, s[56:59], s65 offen sc1
L_o_st3:
  s_cmp_lg_u32 s68, 0
  s_cbranch_scc1 L_o_mv0
  v_mov_b32 v144, v112
  v_mov_b32 v145, v113
  v_mov_b32 v146, v114
  v_mov_b32 v147, v115
  v_mov_b32 v148, v116
  v_mov_b32 v149, v117
  v_mov_b32 v150, v118
  v_mov_b32 v151, v119
L_o_mv0:
  s_cmp_lg_u32 s68, 1
  s_cbranch_scc1 L_o_mv1
  v_mov_b32 v152, v120
  v_mov_b32 v153, v121
  v_mov_b32 v154, v122
  v_mov_b32 v155, v123
  v_mov_b32 v156, v124
  v_mov_b32 v157, v125
  v_mov_b32 v158, v126
  v_mov_b32 v159, v127
L_o_mv1:
  s_cmp_lg_u32 s68, 2
  s_cbranch_scc1 L_o_mv2
  v_mov_b32 v160, v128
  v_mov_b32 v161, v129
  v_mov_b32 v162, v130
  v_mov_b32 v163, v131
  v_mov_b32 v164, v132
  v_mov_b32 v165, v133
  v_mov_b32 v166, v134
  v_mov_b32 v167, v135
L_o_mv2:
  s_cmp_lg_u32 s68, 3
  s_cbranch_scc1 L_o_mv3
  v_mov_b32 v168, v136
  v_mov_b32 v169, v137
  v_mov_b32 v170, v138
  v_mov_b32 v171, v139
  v_mov_b32 v172, v140
  v_mov_b32 v173, v141
  v_mov_b32 v174, v142
  v_mov_b32 v175, v143
L_o_mv3:
  s_waitcnt vmcnt(0) lgkmcnt(0)
  s_barrier
  s_cmp_lg_u32 s3, 4
  s_cbranch_scc1 L_o_nopoll
  s_mov_b64 exec, 1
  v_mov_b32 v0, 1
  s_lshr_b32 s65, s2, 2
  s_lshl_b32 s65, s65, 8
  s_add_u32 s65, s65, 100663296
  s_add_u32 s66, s65, s68
  buffer_store_byte v0, off, s[56:59], s66 sc1
L_o_poll:
  buffer_load_dword v0, off, s[56:59], s65 sc1
  s_waitcnt vmcnt(0)
  v_readfirstlane_b32 s66, v0
  s_cmp_eq_u32 s66, 0x01010101
  s_cbranch_scc1 L_o_polld
  s_sleep 4
  s_branch L_o_poll
L_o_polld:
  s_mov_b64 exec, -1
L_o_nopoll:
  s_barrier
  s_lshl_b32 s66, s68, 13
  s_add_u32 s66, s66, s75
  s_cmp_eq_u32 s68, 0
  s_cbranch_scc1 L_o_ld0
  s_add_u32 s65, s66, 0
  buffer_load_dwordx4 v[176:179], v2, s[56:59], s65 offen sc1
L_o_ld0:
  s_cmp_eq_u32 s68, 1
  s_cbranch_scc1 L_o_ld1
  s_add_u32 s65, s66, 32768
  buffer_load_dwordx4 v[180:183], v2, s[56:59], s65 offen sc1
L_o_ld1:
  s_cmp_eq_u32 s68, 2
  s_cbranch_scc1 L_o_ld2
  s_add_u32 s65, s66, 65536
  buffer_load_dwordx4 v[184:187], v2, s[56:59], s65 offen sc1
L_o_ld2:
  s_cmp_eq_u32 s68, 3
  s_cbranch_scc1 L_o_ld3
  s_add_u32 s65, s66, 98304
  buffer_load_dwordx4 v[188:191], v2, s[56:59], s65 offen sc1
L_o_ld3:
  v_lshlrev_b32 v24, 16, v12
  v_and_b32 v25, 0xffff0000, v12
  v_lshlrev_b32 v26, 16, v13
  v_and_b32 v27, 0xffff0000, v13
  v_lshlrev_b32 v28, 16, v14
  v_and_b32 v29, 0xffff0000, v14
  v_lshlrev_b32 v30, 16, v15
  v_and_b32 v31, 0xffff0000, v15
  s_mov_b32 s65, 0xbfb8aa3b
  s_waitcnt vmcnt(0)
  s_cmp_eq_u32 s68, 0
  s_cbranch_scc1 L_o_up0
  v_lshlrev_b32 v144, 16, v176
  v_and_b32 v145, 0xffff0000, v176
  v_lshlrev_b32 v146, 16, v177
  v_and_b32 v147, 0xffff0000, v177
  v_lshlrev_b32 v148, 16, v178
  v_and_b32 v149, 0xffff0000, v178
  v_lshlrev_b32 v150, 16, v179
  v_and_b32 v151, 0xffff0000, v179
L_o_up0:
  s_cmp_eq_u32 s68, 1
  s_cbranch_scc1 L_o_up1
  v_lshlrev_b32 v152, 16, v180
  v_and_b32 v153, 0xffff0000, v180
  v_lshlrev_b32 v154, 16, v181
  v_and_b32 v155, 0xffff0000, v181
  v_lshlrev_b32 v156, 16, v182
  v_and_b32 v157, 0xffff0000, v182
  v_lshlrev_b32 v158, 16, v183
  v_and_b32 v159, 0xffff0000, v183
L_o_up1:
  s_cmp_eq_u32 s68, 2
  s_cbranch_scc1 L_o_up2
  v_lshlrev_b32 v160, 16, v184
  v_and_b32 v161, 0xffff0000, v184
  v_lshlrev_b32 v162, 16, v185
  v_and_b32 v163, 0xffff0000, v185
  v_lshlrev_b32 v164, 16, v186
  v_and_b32 v165, 0xffff0000, v186
  v_lshlrev_b32 v166, 16, v187
  v_and_b32 v167, 0xffff0000, v187
L_o_up2:
  s_cmp_eq_u32 s68, 3
  s_cbranch_scc1 L_o_up3
  v_lshlrev_b32 v168, 16, v188
  v_and_b32 v169, 0xffff0000, v188
  v_lshlrev_b32 v170, 16, v189
  v_and_b32 v171, 0xffff0000, v189
  v_lshlrev_b32 v172, 16, v190
  v_and_b32 v173, 0xffff0000, v190
  v_lshlrev_b32 v174, 16, v191
  v_and_b32 v175, 0xffff0000, v191
L_o_up3:
  v_mul_f32 v16, s65, v168
  v_mul_f32 v17, s65, v169
  v_mul_f32 v18, s65, v170
  v_mul_f32 v19, s65, v171
  v_mul_f32 v20, s65, v172
  v_mul_f32 v21, s65, v173
  v_mul_f32 v22, s65, v174
  v_mul_f32 v23, s65, v175
  v_exp_f32 v16, v16
  v_exp_f32 v17, v17
  v_exp_f32 v18, v18
  v_exp_f32 v19, v19
  v_exp_f32 v20, v20
  v_exp_f32 v21, v21
  v_exp_f32 v22, v22
  v_exp_f32 v23, v23
  v_add_f32 v144, v144, v152
  v_add_f32 v145, v145, v153
  v_add_f32 v146, v146, v154
  v_add_f32 v147, v147, v155
  v_add_f32 v148, v148, v156
  v_add_f32 v149, v149, v157
  v_add_f32 v150, v150, v158
  v_add_f32 v151, v151, v159
  v_add_f32 v16, 1.0, v16
  v_add_f32 v17, 1.0, v17
  v_add_f32 v18, 1.0, v18
  v_add_f32 v19, 1.0, v19
  v_add_f32 v20, 1.0, v20
  v_add_f32 v21, 1.0, v21
  v_add_f32 v22, 1.0, v22
  v_add_f32 v23, 1.0, v23
  v_rcp_f32 v16, v16
  v_rcp_f32 v17, v17
  v_rcp_f32 v18, v18
  v_rcp_f32 v19, v19
  v_rcp_f32 v20, v20
  v_rcp_f32 v21, v21
  v_rcp_f32 v22, v22
  v_rcp_f32 v23, v23
  v_add_f32 v144, v144, v160
  v_add_f32 v145, v145, v161
  v_add_f32 v146, v146, v162
  v_add_f32 v147, v147, v163
  v_add_f32 v148, v148, v164
  v_add_f32 v149, v149, v165
  v_add_f32 v150, v150, v166
  v_add_f32 v151, v151, v167
  v_mul_f32 v168, v168, v16
  v_mul_f32 v169, v169, v17
  v_mul_f32 v170, v170, v18
  v_mul_f32 v171, v171, v19
  v_mul_f32 v172, v172, v20
  v_mul_f32 v173, v173, v21
  v_mul_f32 v174, v174, v22
  v_mul_f32 v175, v175, v23
  v_fmac_f32 v24, v144, v168
  v_fmac_f32 v25, v145, v169
  v_fmac_f32 v26, v146, v170
  v_fmac_f32 v27, v147, v171
  v_fmac_f32 v28, v148, v172
  v_fmac_f32 v29, v149, v173
  v_fmac_f32 v30, v150, v174
  v_fmac_f32 v31, v151, v175
  v_cvt_pk_bf16_f32 v12, v24, v25
  v_cvt_pk_bf16_f32 v13, v26, v27
  v_cvt_pk_bf16_f32 v14, v28, v29
  v_cvt_pk_bf16_f32 v15, v30, v31
  buffer_store_dwordx2 v[12:13], v7, s[52:55], 0 offen
  buffer_store_dwordx2 v[14:15], v7, s[52:55], 0 offen offset:32
L_main_exit:
  s_endpgm
L_at_mask_f:
  s_add_u32 s65, s74, 3
  s_sub_u32 s65, s65, s82
  s_lshl_b32 s65, s65, 1
  s_sub_i32 s65, s64, s65
  s_cmp_ge_i32 s65, 2
  s_cbranch_scc1 L_at_maskret_f
  s_cmp_eq_u32 s65, 1
  s_cbranch_scc1 L_at_mask_f_1
  v_mov_b32 v128, v8
  v_mov_b32 v129, v8
  v_mov_b32 v130, v8
  v_mov_b32 v131, v8
  v_mov_b32 v132, v8
  v_mov_b32 v133, v8
  v_mov_b32 v134, v8
  v_mov_b32 v135, v8
  v_mov_b32 v136, v8
  v_mov_b32 v137, v8
  v_mov_b32 v138, v8
  v_mov_b32 v139, v8
  v_mov_b32 v140, v8
  v_mov_b32 v141, v8
  v_mov_b32 v142, v8
  v_mov_b32 v143, v8
  s_cmp_eq_u32 s65, 0
  s_cbranch_scc1 L_at_mask_f_0
  v_mov_b32 v112, v8
  v_mov_b32 v113, v8
  v_mov_b32 v114, v8
  v_mov_b32 v115, v8
  v_mov_b32 v116, v8
  v_mov_b32 v117, v8
  v_mov_b32 v118, v8
  v_mov_b32 v119, v8
  v_mov_b32 v120, v8
  v_mov_b32 v121, v8
  v_mov_b32 v122, v8
  v_mov_b32 v123, v8
  v_mov_b32 v124, v8
  v_mov_b32 v125, v8
  v_mov_b32 v126, v8
  v_mov_b32 v127, v8
  s_branch L_at_maskret_f
L_at_mask_f_0:
  v_cndmask_b32 v112, v112, v8, s[8:9]
  v_cndmask_b32 v113, v113, v8, s[10:11]
  v_cndmask_b32 v114, v114, v8, s[12:13]
  v_cndmask_b32 v115, v115, v8, s[14:15]
  v_cndmask_b32 v124, v124, v8, s[8:9]
  v_cndmask_b32 v125, v125, v8, s[10:11]
  v_cndmask_b32 v126, v126, v8, s[12:13]
  v_cndmask_b32 v127, v127, v8, s[14:15]
  v_mov_b32 v120, v8
  v_mov_b32 v121, v8
  v_mov_b32 v122, v8
  v_mov_b32 v123, v8
  s_branch L_at_maskret_f
L_at_mask_f_1:
  v_cndmask_b32 v128, v128, v8, s[8:9]
  v_cndmask_b32 v129, v129, v8, s[10:11]
  v_cndmask_b32 v130, v130, v8, s[12:13]
  v_cndmask_b32 v131, v131, v8, s[14:15]
  v_cndmask_b32 v140, v140, v8, s[8:9]
  v_cndmask_b32 v141, v141, v8, s[10:11]
  v_cndmask_b32 v142, v142, v8, s[12:13]
  v_cndmask_b32 v143, v143, v8, s[14:15]
  v_mov_b32 v136, v8
  v_mov_b32 v137, v8
  v_mov_b32 v138, v8
  v_mov_b32 v139, v8
  s_branch L_at_maskret_f
L_at_mask_e:
  s_add_u32 s65, s74, 3
  s_sub_u32 s65, s65, s82
  s_lshl_b32 s65, s65, 1
  s_sub_i32 s65, s64, s65
  s_cmp_ge_i32 s65, 2
  s_cbranch_scc1 L_at_maskret_e
  s_cmp_eq_u32 s65, 1
  s_cbranch_scc1 L_at_mask_e_1
  v_mov_b32 v160, v8
  v_mov_b32 v161, v8
  v_mov_b32 v162, v8
  v_mov_b32 v163, v8
  v_mov_b32 v164, v8
  v_mov_b32 v165, v8
  v_mov_b32 v166, v8
  v_mov_b32 v167, v8
  v_mov_b32 v168, v8
  v_mov_b32 v169, v8
  v_mov_b32 v170, v8
  v_mov_b32 v171, v8
  v_mov_b32 v172, v8
  v_mov_b32 v173, v8
  v_mov_b32 v174, v8
  v_mov_b32 v175, v8
  s_cmp_eq_u32 s65, 0
  s_cbranch_scc1 L_at_mask_e_0
  v_mov_b32 v144, v8
  v_mov_b32 v145, v8
  v_mov_b32 v146, v8
  v_mov_b32 v147, v8
  v_mov_b32 v148, v8
  v_mov_b32 v149, v8
  v_mov_b32 v150, v8
  v_mov_b32 v151, v8
  v_mov_b32 v152, v8
  v_mov_b32 v153, v8
  v_mov_b32 v154, v8
  v_mov_b32 v155, v8
  v_mov_b32 v156, v8
  v_mov_b32 v157, v8
  v_mov_b32 v158, v8
  v_mov_b32 v159, v8
  s_branch L_at_maskret_e
L_at_mask_e_0:
  v_cndmask_b32 v144, v144, v8, s[8:9]
  v_cndmask_b32 v145, v145, v8, s[10:11]
  v_cndmask_b32 v146, v146, v8, s[12:13]
  v_cndmask_b32 v147, v147, v8, s[14:15]
  v_cndmask_b32 v156, v156, v8, s[8:9]
  v_cndmask_b32 v157, v157, v8, s[10:11]
  v_cndmask_b32 v158, v158, v8, s[12:13]
  v_cndmask_b32 v159, v159, v8, s[14:15]
  v_mov_b32 v152, v8
  v_mov_b32 v153, v8
  v_mov_b32 v154, v8
  v_mov_b32 v155, v8
  s_branch L_at_maskret_e
L_at_mask_e_1:
  v_cndmask_b32 v160, v160, v8, s[8:9]
  v_cndmask_b32 v161, v161, v8, s[10:11]
  v_cndmask_b32 v162, v162, v8, s[12:13]
  v_cndmask_b32 v163, v163, v8, s[14:15]
  v_cndmask_b32 v172, v172, v8, s[8:9]
  v_cndmask_b32 v173, v173, v8, s[10:11]
  v_cndmask_b32 v174, v174, v8, s[12:13]
  v_cndmask_b32 v175, v175, v8, s[14:15]
  v_mov_b32 v168, v8
  v_mov_b32 v169, v8
  v_mov_b32 v170, v8
  v_mov_b32 v171, v8
  s_branch L_at_maskret_e
L_at_resc_e:
  s_nop 15
  v_max3_f32 v240, v144, v145, v146
  v_max3_f32 v240, v240, v147, v152
  v_max3_f32 v240, v240, v153, v154
  v_max3_f32 v240, v240, v155, v160
  v_max3_f32 v240, v240, v161, v162
  v_max3_f32 v240, v240, v163, v168
  v_max3_f32 v240, v240, v169, v170
  v_max_f32 v240, v240, v171
  v_mov_b32 v247, v240
  s_nop 1
  v_permlane16_swap_b32 v240, v247
  v_max_f32 v240, v240, v247
  v_mov_b32 v247, v240
  s_nop 1
  v_permlane32_swap_b32 v240, v247
  v_max_f32 v240, v240, v247
  v_max_f32 v240, 0, v240
  v_sub_f32 v241, 0, v240
  v_exp_f32 v241, v241
  v_sub_f32 v144, v144, v240
  v_sub_f32 v145, v145, v240
  v_sub_f32 v146, v146, v240
  v_sub_f32 v147, v147, v240
  v_sub_f32 v152, v152, v240
  v_sub_f32 v153, v153, v240
  v_sub_f32 v154, v154, v240
  v_sub_f32 v155, v155, v240
  v_sub_f32 v160, v160, v240
  v_sub_f32 v161, v161, v240
  v_sub_f32 v162, v162, v240
  v_sub_f32 v163, v163, v240
  v_sub_f32 v168, v168, v240
  v_sub_f32 v169, v169, v240
  v_sub_f32 v170, v170, v240
  v_sub_f32 v171, v171, v240
  v_sub_f32 v16, v16, v240
  v_sub_f32 v17, v17, v240
  v_sub_f32 v18, v18, v240
  v_sub_f32 v19, v19, v240
  v_mul_f32 v176, v176, v241
  v_mul_f32 v177, v177, v241
  v_mul_f32 v178, v178, v241
  v_mul_f32 v179, v179, v241
  v_mul_f32 v184, v184, v241
  v_mul_f32 v185, v185, v241
  v_mul_f32 v186, v186, v241
  v_mul_f32 v187, v187, v241
  v_mul_f32 v192, v192, v241
  v_mul_f32 v193, v193, v241
  v_mul_f32 v194, v194, v241
  v_mul_f32 v195, v195, v241
  v_mul_f32 v200, v200, v241
  v_mul_f32 v201, v201, v241
  v_mul_f32 v202, v202, v241
  v_mul_f32 v203, v203, v241
  v_mul_f32 v208, v208, v241
  v_mul_f32 v209, v209, v241
  v_mul_f32 v210, v210, v241
  v_mul_f32 v211, v211, v241
  v_mul_f32 v216, v216, v241
  v_mul_f32 v217, v217, v241
  v_mul_f32 v218, v218, v241
  v_mul_f32 v219, v219, v241
  v_mul_f32 v224, v224, v241
  v_mul_f32 v225, v225, v241
  v_mul_f32 v226, v226, v241
  v_mul_f32 v227, v227, v241
  v_mul_f32 v232, v232, v241
  v_mul_f32 v233, v233, v241
  v_mul_f32 v234, v234, v241
  v_mul_f32 v235, v235, v241
  v_mul_f32 v9, v9, v241
  v_max3_f32 v240, v148, v149, v150
  v_max3_f32 v240, v240, v151, v156
  v_max3_f32 v240, v240, v157, v158
  v_max3_f32 v240, v240, v159, v164
  v_max3_f32 v240, v240, v165, v166
  v_max3_f32 v240, v240, v167, v172
  v_max3_f32 v240, v240, v173, v174
  v_max_f32 v240, v240, v175
  v_mov_b32 v247, v240
  s_nop 1
  v_permlane16_swap_b32 v240, v247
  v_max_f32 v240, v240, v247
  v_mov_b32 v247, v240
  s_nop 1
  v_permlane32_swap_b32 v240, v247
  v_max_f32 v240, v240, v247
  v_max_f32 v240, 0, v240
  v_sub_f32 v241, 0, v240
  v_exp_f32 v241, v241
  v_sub_f32 v148, v148, v240
  v_sub_f32 v149, v149, v240
  v_sub_f32 v150, v150, v240
  v_sub_f32 v151, v151, v240
  v_sub_f32 v156, v156, v240
  v_sub_f32 v157, v157, v240
  v_sub_f32 v158, v158, v240
  v_sub_f32 v159, v159, v240
  v_sub_f32 v164, v164, v240
  v_sub_f32 v165, v165, v240
  v_sub_f32 v166, v166, v240
  v_sub_f32 v167, v167, v240
  v_sub_f32 v172, v172, v240
  v_sub_f32 v173, v173, v240
  v_sub_f32 v174, v174, v240
  v_sub_f32 v175, v175, v240
  v_sub_f32 v20, v20, v240
  v_sub_f32 v21, v21, v240
  v_sub_f32 v22, v22, v240
  v_sub_f32 v23, v23, v240
  v_mul_f32 v180, v180, v241
  v_mul_f32 v181, v181, v241
  v_mul_f32 v182, v182, v241
  v_mul_f32 v183, v183, v241
  v_mul_f32 v188, v188, v241
  v_mul_f32 v189, v189, v241
  v_mul_f32 v190, v190, v241
  v_mul_f32 v191, v191, v241
  v_mul_f32 v196, v196, v241
  v_mul_f32 v197, v197, v241
  v_mul_f32 v198, v198, v241
  v_mul_f32 v199, v199, v241
  v_mul_f32 v204, v204, v241
  v_mul_f32 v205, v205, v241
  v_mul_f32 v206, v206, v241
  v_mul_f32 v207, v207, v241
  v_mul_f32 v212, v212, v241
  v_mul_f32 v213, v213, v241
  v_mul_f32 v214, v214, v241
  v_mul_f32 v215, v215, v241
  v_mul_f32 v220, v220, v241
  v_mul_f32 v221, v221, v241
  v_mul_f32 v222, v222, v241
  v_mul_f32 v223, v223, v241
  v_mul_f32 v228, v228, v241
  v_mul_f32 v229, v229, v241
  v_mul_f32 v230, v230, v241
  v_mul_f32 v231, v231, v241
  v_mul_f32 v236, v236, v241
  v_mul_f32 v237, v237, v241
  v_mul_f32 v238, v238, v241
  v_mul_f32 v239, v239, v241
  v_mul_f32 v10, v10, v241
  s_nop 1
  s_branch L_at_rescret_e
L_at_mask_o:
  s_add_u32 s65, s74, 3
  s_sub_u32 s65, s65, s82
  s_lshl_b32 s65, s65, 1
  s_sub_i32 s65, s64, s65
  s_cmp_ge_i32 s65, 2
  s_cbranch_scc1 L_at_maskret_o
  s_cmp_eq_u32 s65, 1
  s_cbranch_scc1 L_at_mask_o_1
  v_mov_b32 v128, v8
  v_mov_b32 v129, v8
  v_mov_b32 v130, v8
  v_mov_b32 v131, v8
  v_mov_b32 v132, v8
  v_mov_b32 v133, v8
  v_mov_b32 v134, v8
  v_mov_b32 v135, v8
  v_mov_b32 v136, v8
  v_mov_b32 v137, v8
  v_mov_b32 v138, v8
  v_mov_b32 v139, v8
  v_mov_b32 v140, v8
  v_mov_b32 v141, v8
  v_mov_b32 v142, v8
  v_mov_b32 v143, v8
  s_cmp_eq_u32 s65, 0
  s_cbranch_scc1 L_at_mask_o_0
  v_mov_b32 v112, v8
  v_mov_b32 v113, v8
  v_mov_b32 v114, v8
  v_mov_b32 v115, v8
  v_mov_b32 v116, v8
  v_mov_b32 v117, v8
  v_mov_b32 v118, v8
  v_mov_b32 v119, v8
  v_mov_b32 v120, v8
  v_mov_b32 v121, v8
  v_mov_b32 v122, v8
  v_mov_b32 v123, v8
  v_mov_b32 v124, v8
  v_mov_b32 v125, v8
  v_mov_b32 v126, v8
  v_mov_b32 v127, v8
  s_branch L_at_maskret_o
L_at_mask_o_0:
  v_cndmask_b32 v112, v112, v8, s[8:9]
  v_cndmask_b32 v113, v113, v8, s[10:11]
  v_cndmask_b32 v114, v114, v8, s[12:13]
  v_cndmask_b32 v115, v115, v8, s[14:15]
  v_cndmask_b32 v124, v124, v8, s[8:9]
  v_cndmask_b32 v125, v125, v8, s[10:11]
  v_cndmask_b32 v126, v126, v8, s[12:13]
  v_cndmask_b32 v127, v127, v8, s[14:15]
  v_mov_b32 v120, v8
  v_mov_b32 v121, v8
  v_mov_b32 v122, v8
  v_mov_b32 v123, v8
  s_branch L_at_maskret_o
L_at_mask_o_1:
  v_cndmask_b32 v128, v128, v8, s[8:9]
  v_cndmask_b32 v129, v129, v8, s[10:11]
  v_cndmask_b32 v130, v130, v8, s[12:13]
  v_cndmask_b32 v131, v131, v8, s[14:15]
  v_cndmask_b32 v140, v140, v8, s[8:9]
  v_cndmask_b32 v141, v141, v8, s[10:11]
  v_cndmask_b32 v142, v142, v8, s[12:13]
  v_cndmask_b32 v143, v143, v8, s[14:15]
  v_mov_b32 v136, v8
  v_mov_b32 v137, v8
  v_mov_b32 v138, v8
  v_mov_b32 v139, v8
  s_branch L_at_maskret_o
L_at_resc_o:
  s_nop 15
  v_max3_f32 v240, v112, v113, v114
  v_max3_f32 v240, v240, v115, v120
  v_max3_f32 v240, v240, v121, v122
  v_max3_f32 v240, v240, v123, v128
  v_max3_f32 v240, v240, v129, v130
  v_max3_f32 v240, v240, v131, v136
  v_max3_f32 v240, v240, v137, v138
  v_max_f32 v240, v240, v139
  v_mov_b32 v247, v240
  s_nop 1
  v_permlane16_swap_b32 v240, v247
  v_max_f32 v240, v240, v247
  v_mov_b32 v247, v240
  s_nop 1
  v_permlane32_swap_b32 v240, v247
  v_max_f32 v240, v240, v247
  v_max_f32 v240, 0, v240
  v_sub_f32 v241, 0, v240
  v_exp_f32 v241, v241
  v_sub_f32 v112, v112, v240
  v_sub_f32 v113, v113, v240
  v_sub_f32 v114, v114, v240
  v_sub_f32 v115, v115, v240
  v_sub_f32 v120, v120, v240
  v_sub_f32 v121, v121, v240
  v_sub_f32 v122, v122, v240
  v_sub_f32 v123, v123, v240
  v_sub_f32 v128, v128, v240
  v_sub_f32 v129, v129, v240
  v_sub_f32 v130, v130, v240
  v_sub_f32 v131, v131, v240
  v_sub_f32 v136, v136, v240
  v_sub_f32 v137, v137, v240
  v_sub_f32 v138, v138, v240
  v_sub_f32 v139, v139, v240
  v_sub_f32 v16, v16, v240
  v_sub_f32 v17, v17, v240
  v_sub_f32 v18, v18, v240
  v_sub_f32 v19, v19, v240
  v_mul_f32 v176, v176, v241
  v_mul_f32 v177, v177, v241
  v_mul_f32 v178, v178, v241
  v_mul_f32 v179, v179, v241
  v_mul_f32 v184, v184, v241
  v_mul_f32 v185, v185, v241
  v_mul_f32 v186, v186, v241
  v_mul_f32 v187, v187, v241
  v_mul_f32 v192, v192, v241
  v_mul_f32 v193, v193, v241
  v_mul_f32 v194, v194, v241
  v_mul_f32 v195, v195, v241
  v_mul_f32 v200, v200, v241
  v_mul_f32 v201, v201, v241
  v_mul_f32 v202, v202, v241
  v_mul_f32 v203, v203, v241
  v_mul_f32 v208, v208, v241
  v_mul_f32 v209, v209, v241
  v_mul_f32 v210, v210, v241
  v_mul_f32 v211, v211, v241
  v_mul_f32 v216, v216, v241
  v_mul_f32 v217, v217, v241
  v_mul_f32 v218, v218, v241
  v_mul_f32 v219, v219, v241
  v_mul_f32 v224, v224, v241
  v_mul_f32 v225, v225, v241
  v_mul_f32 v226, v226, v241
  v_mul_f32 v227, v227, v241
  v_mul_f32 v232, v232, v241
  v_mul_f32 v233, v233, v241
  v_mul_f32 v234, v234, v241
  v_mul_f32 v235, v235, v241
  v_mul_f32 v9, v9, v241
  v_max3_f32 v240, v116, v117, v118
  v_max3_f32 v240, v240, v119, v124
  v_max3_f32 v240, v240, v125, v126
  v_max3_f32 v240, v240, v127, v132
  v_max3_f32 v240, v240, v133, v134
  v_max3_f32 v240, v240, v135, v140
  v_max3_f32 v240, v240, v141, v142
  v_max_f32 v240, v240, v143
  v_mov_b32 v247, v240
  s_nop 1
  v_permlane16_swap_b32 v240, v247
  v_max_f32 v240, v240, v247
  v_mov_b32 v247, v240
  s_nop 1
  v_permlane32_swap_b32 v240, v247
  v_max_f32 v240, v240, v247
  v_max_f32 v240, 0, v240
  v_sub_f32 v241, 0, v240
  v_exp_f32 v241, v241
  v_sub_f32 v116, v116, v240
  v_sub_f32 v117, v117, v240
  v_sub_f32 v118, v118, v240
  v_sub_f32 v119, v119, v240
  v_sub_f32 v124, v124, v240
  v_sub_f32 v125, v125, v240
  v_sub_f32 v126, v126, v240
  v_sub_f32 v127, v127, v240
  v_sub_f32 v132, v132, v240
  v_sub_f32 v133, v133, v240
  v_sub_f32 v134, v134, v240
  v_sub_f32 v135, v135, v240
  v_sub_f32 v140, v140, v240
  v_sub_f32 v141, v141, v240
  v_sub_f32 v142, v142, v240
  v_sub_f32 v143, v143, v240
  v_sub_f32 v20, v20, v240
  v_sub_f32 v21, v21, v240
  v_sub_f32 v22, v22, v240
  v_sub_f32 v23, v23, v240
  v_mul_f32 v180, v180, v241
  v_mul_f32 v181, v181, v241
  v_mul_f32 v182, v182, v241
  v_mul_f32 v183, v183, v241
  v_mul_f32 v188, v188, v241
  v_mul_f32 v189, v189, v241
  v_mul_f32 v190, v190, v241
  v_mul_f32 v191, v191, v241
  v_mul_f32 v196, v196, v241
  v_mul_f32 v197, v197, v241
  v_mul_f32 v198, v198, v241
  v_mul_f32 v199, v199, v241
  v_mul_f32 v204, v204, v241
  v_mul_f32 v205, v205, v241
  v_mul_f32 v206, v206, v241
  v_mul_f32 v207, v207, v241
  v_mul_f32 v212, v212, v241
  v_mul_f32 v213, v213, v241
  v_mul_f32 v214, v214, v241
  v_mul_f32 v215, v215, v241
  v_mul_f32 v220, v220, v241
  v_mul_f32 v221, v221, v241
  v_mul_f32 v222, v222, v241
  v_mul_f32 v223, v223, v241
  v_mul_f32 v228, v228, v241
  v_mul_f32 v229, v229, v241
  v_mul_f32 v230, v230, v241
  v_mul_f32 v231, v231, v241
  v_mul_f32 v236, v236, v241
  v_mul_f32 v237, v237, v241
  v_mul_f32 v238, v238, v241
  v_mul_f32 v239, v239, v241
  v_mul_f32 v10, v10, v241
  s_nop 1
  s_branch L_at_rescret_o
L_o_w1:
  s_waitcnt vmcnt(0) lgkmcnt(0)
  s_branch L_o_j1
L_o_w6:
  s_waitcnt vmcnt(0) lgkmcnt(0)
  s_branch L_o_j6
.section .rodata,"a"
.p2align 6
.amdhsa_kernel main_kernel
  .amdhsa_next_free_vgpr 256
  .amdhsa_next_free_sgpr 102
  .amdhsa_accum_offset 256
  .amdhsa_group_segment_fixed_size 0
  .amdhsa_kernarg_size 104
  .amdhsa_user_sgpr_count 2
  .amdhsa_user_sgpr_kernarg_segment_ptr 1
  .amdhsa_system_sgpr_workgroup_id_x 1
.end_amdhsa_kernel
.text
```
